```python
import torch

def _softmax(x, axis=-1):
    return torch.softmax(x, dim=axis)
def _gelu(x):
    return torch.nn.functional.gelu(x, approximate="tanh")
def _silu(x):
    return torch.nn.functional.silu(x)
def _sigmoid(x):
    return torch.sigmoid(x)
def _layernorm(x, axis=-1, eps=1e-5):
    m = x.mean(dim=axis, keepdim=True)
    v = x.var(dim=axis, keepdim=True, unbiased=False)
    return (x - m) / torch.sqrt(v + eps)
def _scatter_add(tgt, idx, src, axis=0):
    return tgt.clone().index_add_(axis, idx, src)
def _segment_sum(src, seg, n):
    out = torch.zeros((n,) + src.shape[1:], dtype=src.dtype)
    return out.index_add_(0, seg, src)
def _pad(x, pw):
    flat = tuple(v for pair in reversed(pw) for v in pair)
    return torch.nn.functional.pad(x, flat)

kernel_name = 'sequential_preLN__sliding_block_cached__geglu_ffn__decode'

def setup_inputs():

    _w = (lambda a: (lambda t: t.to(torch.bfloat16) if t.is_floating_point() else t)(torch.as_tensor(a)))
    def _A_setup():
        B, Sq, D = 1, 1, 1024
        Hq, Hkv, Sk, Dh = 32, 4, 65536, 128
        assert Hq % Hkv == 0, (Hq, Hkv)
        return {
            "x": _w((lambda *s: torch.randn(*s, dtype=torch.bfloat16) * 0.05)(B, Sq, D)),
            "k_cache": _w((lambda *s: torch.randn(*s, dtype=torch.bfloat16) * 3.2)(B, Hkv, Sk, Dh)),
            "v_cache": _w((lambda *s: torch.randn(*s, dtype=torch.bfloat16) * 0.4)(B, Hkv, Sk, Dh)),
            "wq": _w((lambda *s: torch.randn(*s, dtype=torch.bfloat16) * 3.2)(D, Hq * Dh) * (D ** -0.5)),
            "wo": _w((lambda *s: torch.randn(*s, dtype=torch.bfloat16) * 0.4)(Hq * Dh, D) * ((Hq * Dh) ** -0.5)),
        }
    _A_in = _A_setup()

    def _B_setup():
        B, S, D, F = 1, 1, 1024, 3584
        return {
            "x": _w((lambda *s: torch.randn(*s, dtype=torch.bfloat16) * 0.05)(B, S, D)),
            "w_gate": _w((lambda *s: torch.randn(*s, dtype=torch.bfloat16) * 0.05)(D, F)),
            "w_up": _w((lambda *s: torch.randn(*s, dtype=torch.bfloat16) * 0.05)(D, F)),
            "w_down": _w((lambda *s: torch.randn(*s, dtype=torch.bfloat16) * 0.05)(F, D)),
        }
    _B_in = _B_setup()

    return {
        "A_x": _A_in["x"],
        "A_k_cache": _A_in["k_cache"],
        "A_v_cache": _A_in["v_cache"],
        "A_wq": _A_in["wq"],
        "A_wo": _A_in["wo"],
        "B_x": _B_in["x"],
        "B_w_gate": _B_in["w_gate"],
        "B_w_up": _B_in["w_up"],
        "B_w_down": _B_in["w_down"],
    }

def reference(A_x, A_k_cache, A_v_cache, A_wq, A_wo, B_x, B_w_gate, B_w_up, B_w_down):
    def _A_ref(x, k_cache, v_cache, wq, wo):
        B, Sq, D = x.shape
        Hq, Dh = 32, 128
        Hkv, Sk = k_cache.shape[1], k_cache.shape[2]
        W = min(4096, max(256, Sk // 4))
        rep = Hq // Hkv
        q = (lambda x, *d: x.permute(*d))((x @ wq).reshape(B, Sq, Hq, Dh), 0, 2, 1, 3)
        k = (lambda x, n, axis: torch.repeat_interleave(x, n, dim=axis))(k_cache[:, :, Sk - W:, :], rep, axis=1)
        v = (lambda x, n, axis: torch.repeat_interleave(x, n, dim=axis))(v_cache[:, :, Sk - W:, :], rep, axis=1)
        scores = torch.einsum("bhqd,bhkd->bhqk", q, k) * (Dh ** -0.5)
        p = _softmax(scores, axis=-1)
        o = torch.einsum("bhqk,bhkd->bhqd", p, v)
        return (lambda x, *d: x.permute(*d))(o, 0, 2, 1, 3).reshape(B, Sq, Hq * Dh) @ wo

    def _B_ref(x, w_gate, w_up, w_down):
        return (_gelu(x @ w_gate) * (x @ w_up)) @ w_down

    x = A_x
    h = x + _A_ref(_layernorm(x, axis=-1), A_k_cache, A_v_cache, A_wq, A_wo)
    h2 = h + _B_ref(_layernorm(h, axis=-1), B_w_gate, B_w_up, B_w_down)
    return h2
```

```asm
; @launch grid=(256,1,1) block=(512,1,1) lds=92160
.amdgcn_target "amdgcn-amd-amdhsa--gfx950"
.text
.globl sequential_preLN__sliding_block_cached__geglu_ffn__decode_kernel
.p2align 8
.type sequential_preLN__sliding_block_cached__geglu_ffn__decode_kernel,@function
sequential_preLN__sliding_block_cached__geglu_ffn__decode_kernel:
    s_cmpk_ge_u32 s2, 0x100
    s_cbranch_scc1 L_end
    s_load_dwordx16 s[4:19], s[0:1], 0
    s_load_dwordx8 s[20:27], s[0:1], 64
    v_lshrrev_b32 v1, 6, v0
    v_and_b32 v0, 63, v0
    v_readfirstlane_b32 s3, v1
    s_and_b32 s28, s2, 7
    s_bfe_u32 s29, s2, 0x40003
    s_cmp_lt_u32 s3, 4
    s_cbranch_scc1 L_Q
    s_mov_b64 exec, 0
    s_cmp_eq_u32 s3, 4
    s_cbranch_scc1 PAD_Q0
L_hi:
    s_bitcmp1_b32 s2, 7
    s_cbranch_scc1 L_AG
    s_branch L_BW
L_Q:
    v_lshrrev_b32 v1, 3, v0
    v_lshlrev_b32 v169, 16, v1
    v_lshlrev_b32 v170, 4, v1
    v_and_b32 v1, 7, v0
    v_lshl_add_u32 v169, v1, 4, v169
    v_and_b32 v1, 3, v0
    v_lshl_add_u32 v170, v1, 1, v170
    v_lshlrev_b32 v74, 5, v0
    s_and_b32 s96, s29, 12
    s_add_u32 s96, s96, s3
    s_lshl_b32 s97, s96, 7
    v_add_u32 v170, s97, v170
    s_lshl_b32 s96, s96, 19
    s_and_b32 s97, s29, 3
    s_lshr_b32 s98, s2, 7
    s_lshl2_add_u32 s97, s98, s97
    s_lshl3_add_u32 s97, s28, s97
    s_lshl_b32 s98, s97, 7
    s_add_u32 s60, s96, s98
    s_waitcnt lgkmcnt(0)
    s_load_dword s33, s[26:27], 0
    global_load_dwordx4 v[48:51], v74, s[4:5]
    global_load_dwordx4 v[52:55], v74, s[4:5] offset:16
    global_load_ushort v72, v170, s[4:5]
    global_load_ushort v73, v170, s[4:5] offset:8
    s_add_u32 s60, s10, s60
    s_addc_u32 s61, s11, 0
    global_load_dwordx4 v[16:19], v169, s[60:61] nt
    v_add_u32 v169, 0x2000, v169
    global_load_dwordx4 v[20:23], v169, s[60:61] nt
    v_add_u32 v169, 0x2000, v169
    global_load_dwordx4 v[24:27], v169, s[60:61] nt
PAD_Q0:
    s_cbranch_execz L_hi
    v_add_u32 v169, 0x2000, v169
    global_load_dwordx4 v[28:31], v169, s[60:61] nt
    v_add_u32 v169, 0x2000, v169
    global_load_dwordx4 v[32:35], v169, s[60:61] nt
    v_add_u32 v169, 0x2000, v169
    global_load_dwordx4 v[36:39], v169, s[60:61] nt
    v_add_u32 v169, 0x2000, v169
    global_load_dwordx4 v[40:43], v169, s[60:61] nt
    v_add_u32 v169, 0x2000, v169
    global_load_dwordx4 v[44:47], v169, s[60:61] nt
    s_barrier
    v_and_b32 v2, 15, v0
    v_lshrrev_b32 v3, 4, v0
    s_lshr_b32 s30, s28, 1
    s_mov_b32 s40, 1000000
    s_and_b32 s31, s3, 3
    s_mov_b64 exec, 0
    s_cmp_eq_u32 s31, 0
    s_cbranch_scc1 PAD_Q1
RET_Q2:
    s_mov_b64 exec, -1
    s_lshr_b32 s98, s97, 1
    s_lshl_b32 s62, s98, 11
    s_and_b32 s97, s97, 1
    s_lshl_b32 s97, s97, 8
    s_add_u32 s62, s62, s97
    s_lshr_b32 s96, s29, 2
    s_lshl_b32 s96, s96, 9
    s_add_u32 s62, s62, s96
    s_add_u32 s62, s62, 65536
    s_add_u32 s62, s26, s62
    s_addc_u32 s63, s27, 0
    s_mov_b32 s34, 0x07060500
    s_mov_b32 s35, 0x07060501
    s_mov_b32 s36, 0x07060502
    s_mov_b32 s37, 0x07060503
    s_mov_b32 s38, 0x04000c0c
    s_mov_b32 s39, 0x0706000c
    s_mov_b32 s42, 0x3fb8aa3b
    s_mov_b32 s43, 0x3fb8aa3b
    s_mov_b32 s41, 0
    v_mov_b32 v6, 0
    v_mov_b32 v7, 1
    v_mov_b32 v12, s31
    v_lshlrev_b32 v12, 2, v12
    v_lshlrev_b32 v14, 4, v0
    v_and_b32 v1, 1, v2
    v_lshlrev_b32 v1, 4, v1
    v_mov_b32 v11, 0xffff
    v_lshlrev_b32 v1, v1, v11
    v_lshrrev_b32 v15, 1, v2
    v_and_b32 v15, 3, v15
    v_cmp_eq_u32 vcc, 0, v15
    s_nop 1
    v_cndmask_b32 v8, 0, v1, vcc
    v_cmp_eq_u32 vcc, 1, v15
    s_nop 1
    v_cndmask_b32 v9, 0, v1, vcc
    v_cmp_eq_u32 vcc, 2, v15
    s_nop 1
    v_cndmask_b32 v10, 0, v1, vcc
    v_cmp_eq_u32 vcc, 3, v15
    s_nop 1
    v_cndmask_b32 v11, 0, v1, vcc
    v_and_b32 v1, 1, v3
    v_lshlrev_b32 v1, 4, v1
    v_lshl_or_b32 v13, v2, 5, v1
    v_lshrrev_b32 v1, 2, v2
    v_xor_b32 v1, v1, v3
    v_and_b32 v1, 2, v1
    v_lshl_or_b32 v13, v1, 10, v13
    s_lshl_b32 s96, s31, 9
    v_add_u32 v13, s96, v13
    v_lshlrev_b32 v171, 4, v2
    s_waitcnt vmcnt(8)
    v_lshlrev_b32 v56, 16, v48
    v_and_b32 v57, 0xffff0000, v48
    v_lshlrev_b32 v58, 16, v49
    v_and_b32 v59, 0xffff0000, v49
    v_lshlrev_b32 v60, 16, v50
    v_and_b32 v61, 0xffff0000, v50
    v_lshlrev_b32 v62, 16, v51
    v_and_b32 v63, 0xffff0000, v51
    v_lshlrev_b32 v64, 16, v52
    v_and_b32 v65, 0xffff0000, v52
    v_lshlrev_b32 v66, 16, v53
    v_and_b32 v67, 0xffff0000, v53
    v_lshlrev_b32 v68, 16, v54
    v_and_b32 v69, 0xffff0000, v54
    v_lshlrev_b32 v70, 16, v55
    v_and_b32 v71, 0xffff0000, v55
    v_pk_add_f32 v[74:75], v[56:57], v[58:59]
    v_pk_add_f32 v[74:75], v[74:75], v[60:61]
    v_pk_add_f32 v[74:75], v[74:75], v[62:63]
    v_pk_add_f32 v[74:75], v[74:75], v[64:65]
    v_pk_add_f32 v[74:75], v[74:75], v[66:67]
    v_pk_add_f32 v[74:75], v[74:75], v[68:69]
    v_pk_add_f32 v[74:75], v[74:75], v[70:71]
    v_add_f32 v74, v74, v75
    s_nop 1
    v_add_f32_dpp v74, v74, v74 quad_perm:[1,0,3,2] row_mask:0xf bank_mask:0xf
    s_nop 1
    v_add_f32_dpp v74, v74, v74 quad_perm:[2,3,0,1] row_mask:0xf bank_mask:0xf
    s_nop 1
    v_add_f32_dpp v74, v74, v74 row_ror:4 row_mask:0xf bank_mask:0xf
    s_nop 1
    v_add_f32_dpp v74, v74, v74 row_ror:8 row_mask:0xf bank_mask:0xf
    v_mov_b32 v78, v74
    s_nop 1
    v_permlane16_swap_b32 v74, v78
    v_add_f32 v74, v74, v78
    v_mov_b32 v78, v74
    s_nop 1
    v_permlane32_swap_b32 v74, v78
    v_add_f32 v74, v74, v78
    v_mul_f32 v74, 0x3a800000, v74
    v_pk_add_f32 v[56:57], v[56:57], v[74:75] op_sel_hi:[1,0] neg_lo:[0,1] neg_hi:[0,1]
    v_pk_add_f32 v[58:59], v[58:59], v[74:75] op_sel_hi:[1,0] neg_lo:[0,1] neg_hi:[0,1]
    v_pk_add_f32 v[60:61], v[60:61], v[74:75] op_sel_hi:[1,0] neg_lo:[0,1] neg_hi:[0,1]
    v_pk_add_f32 v[62:63], v[62:63], v[74:75] op_sel_hi:[1,0] neg_lo:[0,1] neg_hi:[0,1]
    v_pk_add_f32 v[64:65], v[64:65], v[74:75] op_sel_hi:[1,0] neg_lo:[0,1] neg_hi:[0,1]
    v_pk_add_f32 v[66:67], v[66:67], v[74:75] op_sel_hi:[1,0] neg_lo:[0,1] neg_hi:[0,1]
    v_pk_add_f32 v[68:69], v[68:69], v[74:75] op_sel_hi:[1,0] neg_lo:[0,1] neg_hi:[0,1]
    v_pk_add_f32 v[70:71], v[70:71], v[74:75] op_sel_hi:[1,0] neg_lo:[0,1] neg_hi:[0,1]
    v_pk_mul_f32 v[76:77], v[56:57], v[56:57]
    v_pk_fma_f32 v[76:77], v[58:59], v[58:59], v[76:77]
    v_pk_fma_f32 v[76:77], v[60:61], v[60:61], v[76:77]
    v_pk_fma_f32 v[76:77], v[62:63], v[62:63], v[76:77]
    v_pk_fma_f32 v[76:77], v[64:65], v[64:65], v[76:77]
    v_pk_fma_f32 v[76:77], v[66:67], v[66:67], v[76:77]
    v_pk_fma_f32 v[76:77], v[68:69], v[68:69], v[76:77]
    v_pk_fma_f32 v[76:77], v[70:71], v[70:71], v[76:77]
    v_add_f32 v76, v76, v77
    s_nop 1
    v_add_f32_dpp v76, v76, v76 quad_perm:[1,0,3,2] row_mask:0xf bank_mask:0xf
    s_nop 1
    v_add_f32_dpp v76, v76, v76 quad_perm:[2,3,0,1] row_mask:0xf bank_mask:0xf
    s_nop 1
    v_add_f32_dpp v76, v76, v76 row_ror:4 row_mask:0xf bank_mask:0xf
    s_nop 1
    v_add_f32_dpp v76, v76, v76 row_ror:8 row_mask:0xf bank_mask:0xf
    v_mov_b32 v78, v76
    s_nop 1
    v_permlane16_swap_b32 v76, v78
    v_add_f32 v76, v76, v78
    v_mov_b32 v78, v76
    s_nop 1
    v_permlane32_swap_b32 v76, v78
    v_add_f32 v76, v76, v78
    v_mul_f32 v76, 0x3a800000, v76
    v_cvt_pk_bf16_f32 v74, v74, v74
    v_lshlrev_b32 v74, 16, v74
    v_cvt_pk_bf16_f32 v76, v76, v76
    v_lshlrev_b32 v76, 16, v76
    v_add_f32 v76, 0x3727c5ac, v76
    v_cvt_pk_bf16_f32 v76, v76, v76
    v_lshlrev_b32 v76, 16, v76
    v_sqrt_f32 v76, v76
    s_nop 0
    v_cvt_pk_bf16_f32 v76, v76, v76
    v_lshlrev_b32 v76, 16, v76
    v_rcp_f32 v77, v76
    v_lshlrev_b32 v72, 16, v72
    v_sub_f32 v72, v72, v74
    v_cvt_pk_bf16_f32 v72, v72, v72
    v_lshlrev_b32 v72, 16, v72
    v_mul_f32 v78, v72, v77
    v_fma_f32 v79, -v78, v76, v72
    v_fma_f32 v78, v79, v77, v78
    v_cvt_pk_bf16_f32 v72, v78, v78
    v_lshlrev_b32 v73, 16, v73
    v_sub_f32 v73, v73, v74
    v_cvt_pk_bf16_f32 v73, v73, v73
    v_lshlrev_b32 v73, 16, v73
    v_mul_f32 v78, v73, v77
    v_fma_f32 v79, -v78, v76, v73
    v_fma_f32 v78, v79, v77, v78
    v_cvt_pk_bf16_f32 v73, v78, v78
    s_waitcnt lgkmcnt(0)
    s_add_u32 s33, s33, 0x9e3779b9
    v_mov_b32 v4, s33
    v_and_b32 v5, 0xff, v4
    v_and_b32_dpp v100, v72, v8 quad_perm:[0,0,0,0] row_mask:0xf bank_mask:0xf
    v_and_b32_dpp v101, v72, v9 quad_perm:[0,0,0,0] row_mask:0xf bank_mask:0xf
    v_and_b32_dpp v102, v72, v10 quad_perm:[0,0,0,0] row_mask:0xf bank_mask:0xf
    v_and_b32_dpp v103, v72, v11 quad_perm:[0,0,0,0] row_mask:0xf bank_mask:0xf
    v_and_b32_dpp v104, v72, v8 quad_perm:[1,1,1,1] row_mask:0xf bank_mask:0xf
    v_and_b32_dpp v105, v72, v9 quad_perm:[1,1,1,1] row_mask:0xf bank_mask:0xf
PAD_Q1:
    s_cbranch_execz RET_Q2
    v_and_b32_dpp v106, v72, v10 quad_perm:[1,1,1,1] row_mask:0xf bank_mask:0xf
    v_and_b32_dpp v107, v72, v11 quad_perm:[1,1,1,1] row_mask:0xf bank_mask:0xf
    s_waitcnt vmcnt(7)
    v_mfma_f32_16x16x32_bf16 v[96:99], v[100:103], v[16:19], 0
    v_and_b32_dpp v100, v72, v8 quad_perm:[2,2,2,2] row_mask:0xf bank_mask:0xf
    v_and_b32_dpp v101, v72, v9 quad_perm:[2,2,2,2] row_mask:0xf bank_mask:0xf
    v_and_b32_dpp v102, v72, v10 quad_perm:[2,2,2,2] row_mask:0xf bank_mask:0xf
    v_and_b32_dpp v103, v72, v11 quad_perm:[2,2,2,2] row_mask:0xf bank_mask:0xf
    s_waitcnt vmcnt(6)
    v_mfma_f32_16x16x32_bf16 v[96:99], v[104:107], v[20:23], v[96:99]
    v_and_b32_dpp v104, v72, v8 quad_perm:[3,3,3,3] row_mask:0xf bank_mask:0xf
    v_and_b32_dpp v105, v72, v9 quad_perm:[3,3,3,3] row_mask:0xf bank_mask:0xf
    v_and_b32_dpp v106, v72, v10 quad_perm:[3,3,3,3] row_mask:0xf bank_mask:0xf
    v_and_b32_dpp v107, v72, v11 quad_perm:[3,3,3,3] row_mask:0xf bank_mask:0xf
    s_waitcnt vmcnt(5)
    v_mfma_f32_16x16x32_bf16 v[96:99], v[100:103], v[24:27], v[96:99]
    v_and_b32_dpp v100, v73, v8 quad_perm:[0,0,0,0] row_mask:0xf bank_mask:0xf
    v_and_b32_dpp v101, v73, v9 quad_perm:[0,0,0,0] row_mask:0xf bank_mask:0xf
    v_and_b32_dpp v102, v73, v10 quad_perm:[0,0,0,0] row_mask:0xf bank_mask:0xf
    v_and_b32_dpp v103, v73, v11 quad_perm:[0,0,0,0] row_mask:0xf bank_mask:0xf
    s_waitcnt vmcnt(4)
    v_mfma_f32_16x16x32_bf16 v[96:99], v[104:107], v[28:31], v[96:99]
    v_and_b32_dpp v104, v73, v8 quad_perm:[1,1,1,1] row_mask:0xf bank_mask:0xf
    v_and_b32_dpp v105, v73, v9 quad_perm:[1,1,1,1] row_mask:0xf bank_mask:0xf
    v_and_b32_dpp v106, v73, v10 quad_perm:[1,1,1,1] row_mask:0xf bank_mask:0xf
    v_and_b32_dpp v107, v73, v11 quad_perm:[1,1,1,1] row_mask:0xf bank_mask:0xf
    s_waitcnt vmcnt(3)
    v_mfma_f32_16x16x32_bf16 v[96:99], v[100:103], v[32:35], v[96:99]
    v_and_b32_dpp v100, v73, v8 quad_perm:[2,2,2,2] row_mask:0xf bank_mask:0xf
    v_and_b32_dpp v101, v73, v9 quad_perm:[2,2,2,2] row_mask:0xf bank_mask:0xf
    v_and_b32_dpp v102, v73, v10 quad_perm:[2,2,2,2] row_mask:0xf bank_mask:0xf
    v_and_b32_dpp v103, v73, v11 quad_perm:[2,2,2,2] row_mask:0xf bank_mask:0xf
    s_waitcnt vmcnt(2)
    v_mfma_f32_16x16x32_bf16 v[96:99], v[104:107], v[36:39], v[96:99]
    v_and_b32_dpp v104, v73, v8 quad_perm:[3,3,3,3] row_mask:0xf bank_mask:0xf
    v_and_b32_dpp v105, v73, v9 quad_perm:[3,3,3,3] row_mask:0xf bank_mask:0xf
    v_and_b32_dpp v106, v73, v10 quad_perm:[3,3,3,3] row_mask:0xf bank_mask:0xf
    v_and_b32_dpp v107, v73, v11 quad_perm:[3,3,3,3] row_mask:0xf bank_mask:0xf
    s_waitcnt vmcnt(1)
    v_mfma_f32_16x16x32_bf16 v[96:99], v[100:103], v[40:43], v[96:99]
    s_waitcnt vmcnt(0)
    v_mfma_f32_16x16x32_bf16 v[96:99], v[104:107], v[44:47], v[96:99]
    s_mov_b64 exec, 1
    ds_add_u32 v12, v7 offset:0
    s_mov_b64 exec, -1
    s_nop 4
    ds_write_b128 v13, v[96:99] offset:4864
    s_mov_b64 exec, 1
    ds_add_rtn_u32 v1, v6, v7 offset:40
    s_mov_b64 exec, -1
    ds_read_b128 v[48:51], v171 offset:4864
    ds_read_b128 v[52:55], v171 offset:5120
    ds_read_b128 v[56:59], v171 offset:5376
    ds_read_b128 v[60:63], v171 offset:5632
    ds_read_b128 v[64:67], v171 offset:5888
    ds_read_b128 v[68:71], v171 offset:6144
    ds_read_b128 v[72:75], v171 offset:6400
    ds_read_b128 v[76:79], v171 offset:6656
    s_waitcnt lgkmcnt(8)
    v_readfirstlane_b32 s96, v1
    s_cmp_eq_u32 s96, 3
    s_cbranch_scc0 pub_1
    s_waitcnt lgkmcnt(0)
    v_pk_add_f32 v[48:49], v[48:49], v[52:53]
    v_pk_add_f32 v[56:57], v[56:57], v[60:61]
    v_pk_add_f32 v[64:65], v[64:65], v[68:69]
    v_pk_add_f32 v[72:73], v[72:73], v[76:77]
    v_pk_add_f32 v[50:51], v[50:51], v[54:55]
    v_pk_add_f32 v[58:59], v[58:59], v[62:63]
    v_pk_add_f32 v[66:67], v[66:67], v[70:71]
    v_pk_add_f32 v[74:75], v[74:75], v[78:79]
    v_pk_add_f32 v[48:49], v[48:49], v[56:57]
    v_pk_add_f32 v[64:65], v[64:65], v[72:73]
    v_pk_add_f32 v[50:51], v[50:51], v[58:59]
    v_pk_add_f32 v[66:67], v[66:67], v[74:75]
    v_pk_add_f32 v[48:49], v[48:49], v[64:65]
    v_pk_add_f32 v[50:51], v[50:51], v[66:67]
    v_perm_b32 v48, v48, v4, s34
    s_mov_b64 exec, 0xffff
    global_store_dwordx4 v171, v[48:51], s[62:63] sc1
    s_mov_b64 exec, -1
pub_1:
    s_waitcnt lgkmcnt(0)
    s_mov_b64 exec, 1
    ds_add_u32 v6, v7 offset:68
    s_mov_b64 exec, -1
    s_bitcmp1_b32 s2, 7
    s_cbranch_scc1 L_AX
    v_and_b32 v1, 1, v3
    v_lshlrev_b32 v1, 1, v1
    v_lshrrev_b32 v126, 2, v2
    v_xor_b32 v1, v1, v126
    v_mov_b32 v11, 0xffff
    v_cmp_eq_u32 vcc, 0, v1
    s_nop 1
    v_cndmask_b32 v8, 0, v11, vcc
    v_cmp_eq_u32 vcc, 1, v1
    s_nop 1
    v_cndmask_b32 v9, 0, v11, vcc
    v_lshlrev_b32 v10, 16, v8
    v_lshlrev_b32 v11, 16, v9
    v_and_b32 v126, 3, v2
    v_mul_u32_u24 v126, 0x5555, v126
L_D:
    s_lshr_b32 s98, s29, 2
    s_mul_i32 s96, s98, 7
    s_add_u32 s96, s96, s3
    s_lshr_b32 s97, s96, 1
    s_lshl_b32 s97, s97, 12
    s_and_b32 s99, s96, 1
    s_lshl_b32 s99, s99, 6
    s_add_u32 s97, s97, s99
    s_lshl_b32 s99, s28, 16
    s_add_u32 s97, s97, s99
    s_add_u32 s97, s97, 1048576
    s_add_u32 s56, s26, s97
    s_addc_u32 s57, s27, 0
    s_mul_i32 s97, s28, 28
    s_add_u32 s96, s96, s97
    s_lshl_b32 s96, s96, 15
    s_and_b32 s99, s29, 3
    s_lshl_b32 s97, s99, 9
    s_add_u32 s96, s96, s97
    s_add_u32 s52, s20, s96
    s_addc_u32 s53, s21, 0
    s_lshl_b32 s97, s28, 2
    s_add_u32 s98, s98, s97
    v_lshrrev_b32 v1, 3, v0
    s_lshl_b32 s96, s99, 3
    v_add_u32 v1, s96, v1
    v_add_u32 v94, s98, v1
    v_and_b32 v94, 31, v94
    v_lshlrev_b32 v94, 7, v94
    v_lshl_add_u32 v94, v1, 12, v94
    v_and_b32 v1, 7, v0
    v_lshl_add_u32 v94, v1, 4, v94
    s_add_u32 s54, s26, 917504
    s_addc_u32 s55, s27, 0
    v_and_b32 v1, 1, v3
    v_mul_u32_u24 v92, 4096, v1
    v_lshrrev_b32 v1, 1, v3
    v_lshl_add_u32 v92, v1, 8, v92
    v_lshl_add_u32 v92, v2, 4, v92
    v_and_b32 v1, 1, v3
    v_lshlrev_b32 v1, 4, v1
    v_lshl_or_b32 v13, v2, 5, v1
    v_lshrrev_b32 v1, 1, v3
    v_lshl_or_b32 v13, v1, 9, v13
    s_mul_i32 s96, s3, 1024
    v_add_u32 v13, s96, v13
    v_lshrrev_b32 v1, 2, v2
    v_lshlrev_b32 v93, 10, v1
    v_lshl_add_u32 v93, v3, 7, v93
    v_and_b32 v1, 3, v2
    v_lshl_add_u32 v93, v1, 4, v93
    v_mov_b32 v95, 0x3a800000
    s_mov_b32 s44, 0x3d372713
    v_mov_b32 v80, 0
    v_mov_b32 v81, 0
    v_mov_b32 v82, 0
    v_mov_b32 v83, 0
gt_2:
    ds_read_b32 v1, v6 offset:64
    s_waitcnt lgkmcnt(0)
    v_readfirstlane_b32 s96, v1
    s_cmp_ge_u32 s96, 4
    s_cbranch_scc1 gd_3
    s_sleep 1
    s_sub_u32 s40, s40, 1
    s_cbranch_scc0 gt_2
    s_mov_b32 s40, 0
gd_3:
    global_load_dwordx4 v[16:19], v92, s[52:53] offset:0 nt
    global_load_dwordx4 v[20:23], v92, s[52:53] offset:2048 nt
    v_add_u32 v92, 0x2000, v92
    global_load_dwordx4 v[24:27], v92, s[52:53] offset:0 nt
    global_load_dwordx4 v[28:31], v92, s[52:53] offset:2048 nt
    v_add_u32 v92, 0x2000, v92
    s_waitcnt vmcnt(3)
    global_load_dwordx4 v[32:35], v92, s[52:53] offset:0 nt
    s_waitcnt vmcnt(3)
    global_load_dwordx4 v[36:39], v92, s[52:53] offset:2048 nt
    v_add_u32 v92, 0x2000, v92
    s_waitcnt vmcnt(3)
    global_load_dwordx4 v[40:43], v92, s[52:53] offset:0 nt
    s_waitcnt vmcnt(3)
    global_load_dwordx4 v[44:47], v92, s[52:53] offset:2048 nt
    s_waitcnt vmcnt(0)
pl_4:
    global_load_dwordx4 v[48:51], v93, s[56:57] offset:0 sc1
    global_load_dwordx4 v[52:55], v93, s[56:57] offset:512 sc1
    s_waitcnt vmcnt(0)
    v_xor_b32 v48, v48, v5
    v_xor_b32 v52, v52, v5
    v_or_b32 v1, v48, v52
    v_cmp_ne_u32_sdwa vcc, v1, v6 src0_sel:BYTE_0 src1_sel:DWORD
    s_cbranch_vccz pd_5
    s_sub_u32 s40, s40, 1
    s_cbranch_scc0 pl_4
    s_mov_b32 s40, 0
pd_5:
    s_setprio 3
    v_perm_b32 v98, v51, v50, s38
    v_perm_b32 v98, v98, v49, s39
    v_perm_b32 v99, v55, v54, s38
    v_perm_b32 v99, v99, v53, s39
    v_pk_add_f32 v[48:49], v[48:49], v[52:53]
    v_pk_add_f32 v[50:51], v[50:51], v[54:55]
    v_add_f32 v98, v98, v99
    s_nop 0
    v_permlane16_swap_b32 v48, v50
    v_mov_b32 v99, v98
    v_permlane16_swap_b32 v49, v51
    s_nop 0
    v_permlane16_swap_b32 v98, v99
    v_pk_add_f32 v[48:49], v[48:49], v[50:51]
    v_add_f32 v98, v98, v99
    v_mov_b32 v99, v98
    v_permlane32_swap_b32 v48, v49
    s_nop 0
    v_permlane32_swap_b32 v98, v99
    v_add_f32 v48, v48, v49
    v_add_f32 v98, v98, v99
    s_nop 1
    v_mul_f32_dpp v99, -v98, v95 row_newbcast:0 row_mask:0xf bank_mask:0xf
    v_mul_f32_dpp v100, v98, v95 row_newbcast:1 row_mask:0xf bank_mask:0xf
    v_fma_f32 v100, -v99, v99, v100
    v_fmac_f32_dpp v48, v48, v99 row_shl:4 row_mask:0xf bank_mask:0x5
    v_max_f32 v100, 0, v100
    v_add_f32 v100, 0x3727c5ac, v100
    v_rsq_f32 v100, v100
    s_nop 0
    v_mul_f32 v48, v48, v100
    v_cvt_pk_bf16_f32 v48, v48, v48
    v_lshlrev_b32 v48, 16, v48
    v_mul_f32 v98, v48, v48
    v_mul_f32 v99, 0xc0135761, v48
    v_fma_f32 v98, v98, s44, 1.0
    v_mul_f32 v98, v98, v99
    v_exp_f32 v98, v98
    s_nop 0
    v_add_f32 v98, 1.0, v98
    v_rcp_f32 v98, v98
    s_nop 0
    v_mul_f32 v98, v98, v48
    v_cvt_pk_bf16_f32 v98, v98, v98
    v_lshlrev_b32 v98, 16, v98
    s_nop 1
    v_mul_f32_dpp v98, v48, v98 row_ror:8 row_mask:0xf bank_mask:0xf
    v_mov_b32 v99, v98
    s_nop 1
    v_permlane16_swap_b32 v98, v99
    v_cvt_pk_bf16_f32 v96, v98, v99
    s_nop 1
    v_and_b32_dpp v84, v96, v8 row_newbcast:0 row_mask:0xf bank_mask:0xf
    v_and_b32_dpp v85, v96, v9 row_newbcast:0 row_mask:0xf bank_mask:0xf
    v_and_b32_dpp v86, v96, v10 row_newbcast:0 row_mask:0xf bank_mask:0xf
    v_and_b32_dpp v87, v96, v11 row_newbcast:0 row_mask:0xf bank_mask:0xf
    v_and_b32_dpp v88, v96, v8 row_newbcast:1 row_mask:0xf bank_mask:0xf
    v_and_b32_dpp v89, v96, v9 row_newbcast:1 row_mask:0xf bank_mask:0xf
    v_and_b32_dpp v90, v96, v10 row_newbcast:1 row_mask:0xf bank_mask:0xf
    v_and_b32_dpp v91, v96, v11 row_newbcast:1 row_mask:0xf bank_mask:0xf
    v_smfmac_f32_16x16x64_bf16 v[80:83], v[84:87], v[16:23], v126
    v_and_b32_dpp v84, v96, v8 row_newbcast:2 row_mask:0xf bank_mask:0xf
    v_and_b32_dpp v85, v96, v9 row_newbcast:2 row_mask:0xf bank_mask:0xf
    v_and_b32_dpp v86, v96, v10 row_newbcast:2 row_mask:0xf bank_mask:0xf
    v_and_b32_dpp v87, v96, v11 row_newbcast:2 row_mask:0xf bank_mask:0xf
    v_smfmac_f32_16x16x64_bf16 v[80:83], v[88:91], v[24:31], v126
    v_and_b32_dpp v88, v96, v8 row_newbcast:3 row_mask:0xf bank_mask:0xf
    v_and_b32_dpp v89, v96, v9 row_newbcast:3 row_mask:0xf bank_mask:0xf
    v_and_b32_dpp v90, v96, v10 row_newbcast:3 row_mask:0xf bank_mask:0xf
    v_and_b32_dpp v91, v96, v11 row_newbcast:3 row_mask:0xf bank_mask:0xf
    v_smfmac_f32_16x16x64_bf16 v[80:83], v[84:87], v[32:39], v126
    s_nop 0
    v_smfmac_f32_16x16x64_bf16 v[80:83], v[88:91], v[40:47], v126
    s_nop 7
    ds_write_b128 v13, v[80:83] offset:9216
    s_mov_b64 exec, 1
    ds_add_rtn_u32 v1, v6, v7 offset:56
    s_mov_b64 exec, -1
    ds_read_b128 v[48:51], v14 offset:9216
    ds_read_b128 v[52:55], v14 offset:10240
    ds_read_b128 v[56:59], v14 offset:11264
    ds_read_b128 v[60:63], v14 offset:12288
    ds_read_b128 v[64:67], v14 offset:13312
    ds_read_b128 v[68:71], v14 offset:14336
    ds_read_b128 v[72:75], v14 offset:15360
    s_waitcnt lgkmcnt(7)
    v_readfirstlane_b32 s96, v1
    s_cmp_eq_u32 s96, 6
    s_cbranch_scc0 pub_6
    s_waitcnt lgkmcnt(0)
    v_pk_add_f32 v[48:49], v[48:49], v[52:53]
    v_pk_add_f32 v[56:57], v[56:57], v[60:61]
    v_pk_add_f32 v[64:65], v[64:65], v[68:69]
    v_pk_add_f32 v[50:51], v[50:51], v[54:55]
    v_pk_add_f32 v[58:59], v[58:59], v[62:63]
    v_pk_add_f32 v[66:67], v[66:67], v[70:71]
    v_pk_add_f32 v[48:49], v[48:49], v[56:57]
    v_pk_add_f32 v[64:65], v[64:65], v[72:73]
    v_pk_add_f32 v[50:51], v[50:51], v[58:59]
    v_pk_add_f32 v[66:67], v[66:67], v[74:75]
    v_pk_add_f32 v[48:49], v[48:49], v[64:65]
    v_pk_add_f32 v[50:51], v[50:51], v[66:67]
    v_perm_b32 v48, v48, v4, s34
    global_store_dwordx4 v94, v[48:51], s[54:55] sc1
    s_waitcnt vmcnt(0)
    s_lshl_b32 s96, s29, 3
    s_add_u32 s96, s96, s3
    s_and_b32 s96, s96, 120
    s_cmp_eq_u32 s96, 0
    s_cbranch_scc0 wb_7
    buffer_wbl2 sc1
wb_7:
pub_6:
    s_waitcnt lgkmcnt(0)
    s_branch L_out
L_BW:
    s_mov_b64 exec, -1
    v_and_b32 v2, 15, v0
    v_lshrrev_b32 v3, 4, v0
    s_lshr_b32 s30, s28, 1
    s_mov_b32 s40, 1000000
    s_and_b32 s31, s3, 3
    s_cmp_eq_u32 s3, 7
    s_cbranch_scc0 zf_8
    v_mov_b32 v1, 0
    v_lshlrev_b32 v124, 2, v0
    ds_write_b32 v124, v1
zf_8:
    s_and_b32 s97, s29, 3
    s_lshl_b32 s98, s28, 2
    s_add_u32 s32, s97, s98
    s_lshl_b32 s99, s32, 2
    s_add_u32 s99, s99, s31
    s_lshl_b32 s96, s99, 16
    s_lshr_b32 s98, s29, 2
    s_lshl_b32 s97, s98, 9
    s_add_u32 s97, s96, s97
    s_waitcnt lgkmcnt(0)
    s_load_dword s33, s[26:27], 0
    s_barrier
    s_add_u32 s52, s12, s97
    s_addc_u32 s53, s13, 0
    s_lshl_b32 s99, s99, 12
    s_add_u32 s99, s99, 262144
    s_add_u32 s56, s26, s99
    s_addc_u32 s57, s27, 0
    s_add_u32 s54, s26, 786432
    s_addc_u32 s55, s27, 0
    v_and_b32 v1, 1, v3
    v_mul_u32_u24 v124, 4096, v1
    v_lshrrev_b32 v1, 1, v3
    v_lshl_add_u32 v124, v1, 8, v124
    v_lshl_add_u32 v124, v2, 4, v124
    s_mov_b32 s34, 0x07060500
    s_mov_b32 s35, 0x07060501
    s_mov_b32 s36, 0x07060502
    s_mov_b32 s37, 0x07060503
    s_mov_b32 s38, 0x04000c0c
    s_mov_b32 s39, 0x0706000c
    s_mov_b32 s42, 0x3fb8aa3b
    s_mov_b32 s43, 0x3fb8aa3b
    s_mov_b32 s41, 0
    v_mov_b32 v6, 0
    v_mov_b32 v7, 1
    v_mov_b32 v12, s31
    v_lshlrev_b32 v12, 2, v12
    v_lshlrev_b32 v14, 4, v0
    v_and_b32 v1, 1, v3
    v_lshlrev_b32 v1, 1, v1
    v_lshrrev_b32 v126, 2, v2
    v_xor_b32 v1, v1, v126
    v_mov_b32 v11, 0xffff
    v_cmp_eq_u32 vcc, 0, v1
    s_nop 1
    v_cndmask_b32 v8, 0, v11, vcc
    v_cmp_eq_u32 vcc, 1, v1
    s_nop 1
    v_cndmask_b32 v9, 0, v11, vcc
    v_lshlrev_b32 v10, 16, v8
    v_lshlrev_b32 v11, 16, v9
    v_and_b32 v126, 3, v2
    v_mul_u32_u24 v126, 0x5555, v126
    v_mov_b32 v96, 0
    v_mov_b32 v97, 0
    v_mov_b32 v98, 0
    v_mov_b32 v99, 0
    v_and_b32 v1, 1, v3
    v_lshlrev_b32 v1, 4, v1
    v_lshl_or_b32 v13, v2, 5, v1
    v_lshrrev_b32 v1, 1, v3
    v_lshl_or_b32 v13, v1, 9, v13
    s_mul_i32 s96, s31, 1024
    v_add_u32 v13, s96, v13
    v_lshrrev_b32 v1, 3, v0
    s_lshl_b32 s96, s98, 3
    v_add_u32 v1, s96, v1
    v_add_u32 v125, s32, v1
    v_and_b32 v125, 31, v125
    v_lshlrev_b32 v125, 7, v125
    v_lshl_add_u32 v125, v1, 12, v125
    v_and_b32 v1, 7, v0
    v_lshl_add_u32 v125, v1, 4, v125
    s_waitcnt lgkmcnt(0)
    s_add_u32 s33, s33, 0x9e3779b9
    v_mov_b32 v4, s33
    v_and_b32 v5, 0xff, v4
    s_cmp_eq_u32 s3, 7
    s_cbranch_scc0 xp_9
    s_getreg_b32 s96, hwreg(HW_REG_XCC_ID, 0, 4)
    s_add_u32 s96, s96, s33
    s_lshl_b32 s97, s28, 7
    s_lshr_b32 s98, s2, 3
    s_lshl_b32 s98, s98, 2
    s_add_u32 s97, s97, s98
    s_add_u32 s97, s97, 4096
    v_mov_b32 v108, s97
    v_mov_b32 v109, s96
    s_mov_b64 exec, 1
    global_store_dword v108, v109, s[26:27] sc1
    s_mov_b64 exec, -1
xp_9:
gt_10:
    ds_read_b32 v1, v6 offset:68
    s_waitcnt lgkmcnt(0)
    v_readfirstlane_b32 s96, v1
    s_cmp_ge_u32 s96, 4
    s_cbranch_scc1 gd_11
    s_sleep 1
    s_sub_u32 s40, s40, 1
    s_cbranch_scc0 gt_10
    s_mov_b32 s40, 0
gd_11:
    global_load_dwordx4 v[16:19], v124, s[52:53] offset:0 nt
    s_waitcnt vmcnt(0)
    global_load_dwordx4 v[20:23], v124, s[52:53] offset:2048 nt
    v_add_u32 v124, 0x2000, v124
    global_load_dwordx4 v[24:27], v124, s[52:53] offset:0 nt
    global_load_dwordx4 v[28:31], v124, s[52:53] offset:2048 nt
    v_add_u32 v124, 0x2000, v124
    global_load_dwordx4 v[32:35], v124, s[52:53] offset:0 nt
    global_load_dwordx4 v[36:39], v124, s[52:53] offset:2048 nt
    v_add_u32 v124, 0x2000, v124
    global_load_dwordx4 v[40:43], v124, s[52:53] offset:0 nt
    global_load_dwordx4 v[44:47], v124, s[52:53] offset:2048 nt
    v_add_u32 v124, 0x2000, v124
    global_load_dwordx4 v[48:51], v124, s[52:53] offset:0 nt
    global_load_dwordx4 v[52:55], v124, s[52:53] offset:2048 nt
    v_add_u32 v124, 0x2000, v124
    global_load_dwordx4 v[56:59], v124, s[52:53] offset:0 nt
    global_load_dwordx4 v[60:63], v124, s[52:53] offset:2048 nt
    v_add_u32 v124, 0x2000, v124
    global_load_dwordx4 v[64:67], v124, s[52:53] offset:0 nt
    global_load_dwordx4 v[68:71], v124, s[52:53] offset:2048 nt
    v_add_u32 v124, 0x2000, v124
    global_load_dwordx4 v[72:75], v124, s[52:53] offset:0 nt
    global_load_dwordx4 v[76:79], v124, s[52:53] offset:2048 nt
    s_waitcnt vmcnt(0)
    s_mov_b64 exec, 0xffff
pr_14:
    global_load_dwordx4 v[80:83], v14, s[56:57] offset:0 sc1
    s_waitcnt vmcnt(0)
    v_xor_b32 v1, v80, v5
    v_cmp_ne_u32_sdwa vcc, v1, v6 src0_sel:BYTE_0 src1_sel:DWORD
    s_cbranch_vccz pq_15
    s_sub_u32 s40, s40, 1
    s_cbranch_scc0 pr_14
    s_mov_b32 s40, 0
pq_15:
    s_mov_b64 exec, -1
pl_12:
    global_load_dwordx4 v[80:83], v14, s[56:57] offset:0 sc1
    global_load_dwordx4 v[84:87], v14, s[56:57] offset:1024 sc1
    global_load_dwordx4 v[88:91], v14, s[56:57] offset:2048 sc1
    global_load_dwordx4 v[92:95], v14, s[56:57] offset:3072 sc1
    s_waitcnt vmcnt(0)
    v_xor_b32 v80, v80, v5
    v_xor_b32 v84, v84, v5
    v_xor_b32 v88, v88, v5
    v_xor_b32 v92, v92, v5
    v_or3_b32 v1, v80, v84, v88
    v_or_b32 v1, v1, v92
    v_cmp_ne_u32_sdwa vcc, v1, v6 src0_sel:BYTE_0 src1_sel:DWORD
    s_cbranch_vccz pd_13
    s_sub_u32 s40, s40, 1
    s_cbranch_scc0 pl_12
    s_mov_b32 s40, 0
pd_13:
    s_setprio 3
    v_perm_b32 v108, v83, v82, s38
    v_perm_b32 v108, v108, v81, s39
    v_perm_b32 v109, v87, v86, s38
    v_perm_b32 v109, v109, v85, s39
    v_perm_b32 v110, v91, v90, s38
    v_perm_b32 v110, v110, v89, s39
    v_perm_b32 v111, v95, v94, s38
    v_perm_b32 v111, v111, v93, s39
    v_max3_f32 v116, v108, v109, v110
    v_max_f32 v116, v116, v111
    s_nop 1
    v_max_f32_dpp v116, v116, v116 row_ror:8 row_mask:0xf bank_mask:0xf
    v_mov_b32 v117, v116
    s_nop 1
    v_permlane16_swap_b32 v116, v117
    v_max_f32 v116, v116, v117
    v_mov_b32 v117, v116
    s_nop 1
    v_permlane32_swap_b32 v116, v117
    v_max_f32 v116, v116, v117
    s_nop 1
    v_mov_b32_dpp v116, v116 quad_perm:[0,0,2,2] row_mask:0xf bank_mask:0xf
    s_nop 1
    v_sub_f32_dpp v112, v108, v116 quad_perm:[0,0,2,2] row_mask:0xf bank_mask:0xf
    v_sub_f32_dpp v113, v109, v116 quad_perm:[0,0,2,2] row_mask:0xf bank_mask:0xf
    v_sub_f32_dpp v114, v110, v116 quad_perm:[0,0,2,2] row_mask:0xf bank_mask:0xf
    v_sub_f32_dpp v115, v111, v116 quad_perm:[0,0,2,2] row_mask:0xf bank_mask:0xf
    v_pk_mul_f32 v[112:113], v[112:113], s[42:43]
    v_pk_mul_f32 v[114:115], v[114:115], s[42:43]
    v_exp_f32 v112, v112
    v_exp_f32 v113, v113
    v_exp_f32 v114, v114
    v_exp_f32 v115, v115
    v_mul_f32 v118, v108, v112
    v_pk_mul_f32 v[120:121], v[80:81], v[112:113] op_sel:[0,0] op_sel_hi:[1,0]
    v_pk_mul_f32 v[122:123], v[82:83], v[112:113] op_sel:[0,0] op_sel_hi:[1,0]
    v_fmac_f32 v118, v109, v113
    v_pk_fma_f32 v[120:121], v[84:85], v[112:113], v[120:121] op_sel:[0,1,0] op_sel_hi:[1,1,1]
    v_pk_fma_f32 v[122:123], v[86:87], v[112:113], v[122:123] op_sel:[0,1,0] op_sel_hi:[1,1,1]
    v_fmac_f32 v118, v110, v114
    v_pk_fma_f32 v[120:121], v[88:89], v[114:115], v[120:121] op_sel:[0,0,0] op_sel_hi:[1,0,1]
    v_pk_fma_f32 v[122:123], v[90:91], v[114:115], v[122:123] op_sel:[0,0,0] op_sel_hi:[1,0,1]
    v_fmac_f32 v118, v111, v115
    v_pk_fma_f32 v[120:121], v[92:93], v[114:115], v[120:121] op_sel:[0,1,0] op_sel_hi:[1,1,1]
    v_pk_fma_f32 v[122:123], v[94:95], v[114:115], v[122:123] op_sel:[0,1,0] op_sel_hi:[1,1,1]
    v_add_f32_dpp v118, v118, v118 row_ror:8 row_mask:0xf bank_mask:0xf
    s_nop 0
    v_permlane16_swap_b32 v120, v122
    v_mov_b32 v117, v118
    v_permlane16_swap_b32 v121, v123
    s_nop 0
    v_permlane16_swap_b32 v118, v117
    v_pk_add_f32 v[120:121], v[120:121], v[122:123]
    v_add_f32 v118, v118, v117
    s_nop 0
    v_permlane32_swap_b32 v120, v121
    v_mov_b32 v117, v118
    v_add_f32 v119, v120, v121
    s_nop 0
    v_permlane32_swap_b32 v118, v117
    v_add_f32_dpp v119, v119, v119 row_ror:8 row_mask:0xf bank_mask:0xf
    v_add_f32 v118, v118, v117
    v_rcp_f32 v118, v118
    s_nop 1
    v_mul_f32_dpp v119, v118, v119 quad_perm:[1,1,3,3] row_mask:0xf bank_mask:0xf
    v_mov_b32 v117, v119
    s_nop 1
    v_permlane16_swap_b32 v119, v117
    v_cvt_pk_bf16_f32 v15, v119, v117
    s_nop 1
    v_and_b32_dpp v100, v15, v8 row_newbcast:0 row_mask:0xf bank_mask:0xf
    v_and_b32_dpp v101, v15, v9 row_newbcast:0 row_mask:0xf bank_mask:0xf
    v_and_b32_dpp v102, v15, v10 row_newbcast:0 row_mask:0xf bank_mask:0xf
    v_and_b32_dpp v103, v15, v11 row_newbcast:0 row_mask:0xf bank_mask:0xf
    v_and_b32_dpp v104, v15, v8 row_newbcast:1 row_mask:0xf bank_mask:0xf
    v_and_b32_dpp v105, v15, v9 row_newbcast:1 row_mask:0xf bank_mask:0xf
    v_and_b32_dpp v106, v15, v10 row_newbcast:1 row_mask:0xf bank_mask:0xf
    v_and_b32_dpp v107, v15, v11 row_newbcast:1 row_mask:0xf bank_mask:0xf
    v_smfmac_f32_16x16x64_bf16 v[96:99], v[100:103], v[16:23], v126
    v_and_b32_dpp v100, v15, v8 row_newbcast:2 row_mask:0xf bank_mask:0xf
    v_and_b32_dpp v101, v15, v9 row_newbcast:2 row_mask:0xf bank_mask:0xf
    v_and_b32_dpp v102, v15, v10 row_newbcast:2 row_mask:0xf bank_mask:0xf
    v_and_b32_dpp v103, v15, v11 row_newbcast:2 row_mask:0xf bank_mask:0xf
    v_smfmac_f32_16x16x64_bf16 v[96:99], v[104:107], v[24:31], v126
    v_and_b32_dpp v104, v15, v8 row_newbcast:3 row_mask:0xf bank_mask:0xf
    v_and_b32_dpp v105, v15, v9 row_newbcast:3 row_mask:0xf bank_mask:0xf
    v_and_b32_dpp v106, v15, v10 row_newbcast:3 row_mask:0xf bank_mask:0xf
    v_and_b32_dpp v107, v15, v11 row_newbcast:3 row_mask:0xf bank_mask:0xf
    v_smfmac_f32_16x16x64_bf16 v[96:99], v[100:103], v[32:39], v126
    v_and_b32_dpp v100, v15, v8 row_newbcast:4 row_mask:0xf bank_mask:0xf
    v_and_b32_dpp v101, v15, v9 row_newbcast:4 row_mask:0xf bank_mask:0xf
    v_and_b32_dpp v102, v15, v10 row_newbcast:4 row_mask:0xf bank_mask:0xf
    v_and_b32_dpp v103, v15, v11 row_newbcast:4 row_mask:0xf bank_mask:0xf
    v_smfmac_f32_16x16x64_bf16 v[96:99], v[104:107], v[40:47], v126
    v_and_b32_dpp v104, v15, v8 row_newbcast:5 row_mask:0xf bank_mask:0xf
    v_and_b32_dpp v105, v15, v9 row_newbcast:5 row_mask:0xf bank_mask:0xf
    v_and_b32_dpp v106, v15, v10 row_newbcast:5 row_mask:0xf bank_mask:0xf
    v_and_b32_dpp v107, v15, v11 row_newbcast:5 row_mask:0xf bank_mask:0xf
    v_smfmac_f32_16x16x64_bf16 v[96:99], v[100:103], v[48:55], v126
    v_and_b32_dpp v100, v15, v8 row_newbcast:6 row_mask:0xf bank_mask:0xf
    v_and_b32_dpp v101, v15, v9 row_newbcast:6 row_mask:0xf bank_mask:0xf
    v_and_b32_dpp v102, v15, v10 row_newbcast:6 row_mask:0xf bank_mask:0xf
    v_and_b32_dpp v103, v15, v11 row_newbcast:6 row_mask:0xf bank_mask:0xf
    v_smfmac_f32_16x16x64_bf16 v[96:99], v[104:107], v[56:63], v126
    v_and_b32_dpp v104, v15, v8 row_newbcast:7 row_mask:0xf bank_mask:0xf
    v_and_b32_dpp v105, v15, v9 row_newbcast:7 row_mask:0xf bank_mask:0xf
    v_and_b32_dpp v106, v15, v10 row_newbcast:7 row_mask:0xf bank_mask:0xf
    v_and_b32_dpp v107, v15, v11 row_newbcast:7 row_mask:0xf bank_mask:0xf
    v_smfmac_f32_16x16x64_bf16 v[96:99], v[100:103], v[64:71], v126
    s_nop 0
    v_smfmac_f32_16x16x64_bf16 v[96:99], v[104:107], v[72:79], v126
    s_nop 7
    ds_write_b128 v13, v[96:99] offset:5120
    s_mov_b64 exec, 1
    ds_add_rtn_u32 v1, v6, v7 offset:44
    s_mov_b64 exec, -1
    ds_read_b128 v[80:83], v14 offset:5120
    ds_read_b128 v[84:87], v14 offset:6144
    ds_read_b128 v[88:91], v14 offset:7168
    ds_read_b128 v[92:95], v14 offset:8192
    s_waitcnt lgkmcnt(4)
    v_readfirstlane_b32 s96, v1
    s_cmp_eq_u32 s96, 3
    s_cbranch_scc0 pub_16
    s_waitcnt lgkmcnt(0)
    v_pk_add_f32 v[80:81], v[80:81], v[84:85]
    v_pk_add_f32 v[88:89], v[88:89], v[92:93]
    v_pk_add_f32 v[82:83], v[82:83], v[86:87]
    v_pk_add_f32 v[90:91], v[90:91], v[94:95]
    v_pk_add_f32 v[80:81], v[80:81], v[88:89]
    v_pk_add_f32 v[82:83], v[82:83], v[90:91]
    v_perm_b32 v80, v80, v4, s34
    global_store_dwordx4 v125, v[80:83], s[54:55] sc1
pub_16:
    s_waitcnt lgkmcnt(0)
    s_mov_b64 exec, 1
    ds_add_u32 v6, v7 offset:64
    s_mov_b64 exec, -1
    s_setprio 0
    s_cmp_eq_u32 s3, 7
    s_cbranch_scc1 L_out
    s_branch L_D
L_AG:
    s_mov_b64 exec, -1
    v_and_b32 v2, 15, v0
    v_lshrrev_b32 v3, 4, v0
    s_lshr_b32 s30, s28, 1
    s_mov_b32 s40, 1000000
    s_and_b32 s31, s3, 3
    v_lshlrev_b32 v1, 1, v3
    v_xor_b32 v1, v1, v2
    v_lshlrev_b32 v1, 4, v1
    v_lshl_add_u32 v210, v3, 8, v1
    v_xor_b32 v211, 0x80, v210
    s_and_b32 s32, s28, 1
    s_lshl_b32 s32, s32, 4
    s_add_u32 s32, s32, s29
    s_lshl_b32 s96, s30, 24
    s_lshl_b32 s97, s32, 15
    s_add_u32 s96, s96, s97
    s_lshl_b32 s99, s31, 13
    s_add_u32 s96, s96, s99
    s_add_u32 s98, s96, 15728640
    s_add_u32 m0, s99, 59392
    s_cmp_eq_u32 s3, 7
    s_cbranch_scc0 zf_17
    v_mov_b32 v1, 0
    v_lshlrev_b32 v204, 2, v0
    ds_write_b32 v204, v1
zf_17:
    v_xor_b32 v1, v3, v2
    v_lshlrev_b32 v1, 4, v1
    v_lshl_add_u32 v172, v3, 8, v1
    v_xor_b32 v173, 64, v172
    v_xor_b32 v174, 0x80, v172
    v_xor_b32 v175, 0xc0, v172
    s_add_u32 m0, s99, 26624
    s_waitcnt lgkmcnt(0)
    s_load_dword s33, s[26:27], 0
    s_add_u32 s52, s8, s98
    s_addc_u32 s53, s9, 0
    s_add_u32 s54, s52, 4096
    s_addc_u32 s55, s53, 0
    s_add_u32 s56, s6, s98
    s_addc_u32 s57, s7, 0
    s_add_u32 s58, s56, 4096
    s_addc_u32 s59, s57, 0
    s_barrier
    global_load_lds_dwordx4 v172, s[56:57] offset:0 nt
    global_load_lds_dwordx4 v173, s[56:57] offset:1024 nt
    global_load_lds_dwordx4 v174, s[56:57] offset:2048 nt
    global_load_lds_dwordx4 v175, s[56:57] offset:3072 nt
    s_add_u32 m0, m0, 4096
    s_nop 0
    global_load_lds_dwordx4 v172, s[58:59] offset:0 nt
    global_load_lds_dwordx4 v173, s[58:59] offset:1024 nt
    global_load_lds_dwordx4 v174, s[58:59] offset:2048 nt
    global_load_lds_dwordx4 v175, s[58:59] offset:3072 nt
    s_add_u32 m0, s99, 59392
    s_mov_b32 s34, 0x07060500
    s_mov_b32 s35, 0x07060501
    s_mov_b32 s36, 0x07060502
    s_mov_b32 s37, 0x07060503
    s_mov_b32 s38, 0x04000c0c
    s_mov_b32 s39, 0x0706000c
    s_mov_b32 s42, 0x3fb8aa3b
    s_mov_b32 s43, 0x3fb8aa3b
    s_mov_b32 s41, 0
    v_mov_b32 v6, 0
    v_mov_b32 v7, 1
    v_mov_b32 v12, s31
    v_lshlrev_b32 v12, 2, v12
    v_lshlrev_b32 v14, 4, v0
    v_and_b32 v1, 1, v2
    v_lshlrev_b32 v1, 4, v1
    v_mov_b32 v11, 0xffff
    v_lshlrev_b32 v1, v1, v11
    v_lshrrev_b32 v15, 1, v2
    v_and_b32 v11, 2, v3
    v_lshlrev_b32 v11, 1, v11
    v_xor_b32 v15, v15, v11
    v_cmp_eq_u32 vcc, 0, v15
    s_nop 1
    v_cndmask_b32 v8, 0, v1, vcc
    v_cmp_eq_u32 vcc, 1, v15
    s_nop 1
    v_cndmask_b32 v9, 0, v1, vcc
    v_cmp_eq_u32 vcc, 2, v15
    s_nop 1
    v_cndmask_b32 v10, 0, v1, vcc
    v_cmp_eq_u32 vcc, 3, v15
    s_nop 1
    v_cndmask_b32 v11, 0, v1, vcc
    v_and_b32 v1, 1, v3
    v_lshlrev_b32 v1, 4, v1
    v_lshl_or_b32 v13, v2, 5, v1
    v_lshrrev_b32 v1, 1, v3
    v_lshl_or_b32 v13, v1, 9, v13
    s_mul_i32 s96, s31, 4096
    v_add_u32 v13, s96, v13
    s_lshr_b32 s32, s29, 1
    s_lshl_b32 s32, s32, 2
    s_add_u32 s32, s32, s31
    v_and_b32 v1, 7, v2
    v_lshlrev_b32 v209, 3, v1
    v_and_b32 v1, 1, v3
    v_lshl_add_u32 v209, v1, 2, v209
    v_lshrrev_b32 v1, 1, v3
    v_lshl_add_u32 v209, v1, 1, v209
    s_lshl_b32 s96, s32, 6
    v_add_u32 v209, s96, v209
    v_and_b32 v168, 0x3f803f80, v8
    v_and_b32 v169, 0x3f803f80, v9
    v_and_b32 v170, 0x3f803f80, v10
    v_and_b32 v171, 0x3f803f80, v11
    v_and_b32 v1, 1, v3
    v_lshlrev_b32 v1, 1, v1
    v_lshrrev_b32 v218, 2, v2
    v_xor_b32 v1, v1, v218
    v_mov_b32 v11, 0xffff
    v_cmp_eq_u32 vcc, 0, v1
    s_nop 1
    v_cndmask_b32 v8, 0, v11, vcc
    v_cmp_eq_u32 vcc, 1, v1
    s_nop 1
    v_cndmask_b32 v9, 0, v11, vcc
    v_lshlrev_b32 v10, 16, v8
    v_lshlrev_b32 v11, 16, v9
    v_and_b32 v218, 3, v2
    v_mul_u32_u24 v218, 0x5555, v218
    v_mov_b32 v144, 0
    v_mov_b32 v145, 0
    v_mov_b32 v146, 0
    v_mov_b32 v147, 0
    v_mov_b32 v148, 0
    v_mov_b32 v149, 0
    v_mov_b32 v150, 0
    v_mov_b32 v151, 0
    s_waitcnt lgkmcnt(0)
    s_add_u32 s33, s33, 0x9e3779b9
    v_mov_b32 v4, s33
    v_and_b32 v5, 0xff, v4
    s_cmp_eq_u32 s3, 7
    s_cbranch_scc0 xp_18
    s_getreg_b32 s96, hwreg(HW_REG_XCC_ID, 0, 4)
    s_add_u32 s96, s96, s33
    s_lshl_b32 s97, s28, 7
    s_lshr_b32 s98, s2, 3
    s_lshl_b32 s98, s98, 2
    s_add_u32 s97, s97, s98
    s_add_u32 s97, s97, 4096
    v_mov_b32 v215, s97
    v_mov_b32 v216, s96
    s_mov_b64 exec, 1
    global_store_dword v215, v216, s[26:27] sc1
    s_mov_b64 exec, -1
xp_18:
    global_load_ushort v205, v209, s[4:5]
gt_19:
    ds_read_b32 v1, v12 offset:0
    s_waitcnt lgkmcnt(0)
    v_readfirstlane_b32 s96, v1
    s_cmp_ge_u32 s96, 1
    s_cbranch_scc1 gd_20
    s_sleep 1
    s_sub_u32 s40, s40, 1
    s_cbranch_scc0 gt_19
    s_mov_b32 s40, 0
gd_20:
    global_load_lds_dwordx4 v210, s[52:53] offset:0 nt
    global_load_lds_dwordx4 v210, s[52:53] offset:1024 nt
    global_load_lds_dwordx4 v211, s[52:53] offset:2048 nt
    global_load_lds_dwordx4 v211, s[52:53] offset:3072 nt
    s_add_u32 m0, s99, 63488
    s_nop 0
    global_load_lds_dwordx4 v210, s[54:55] offset:0 nt
    global_load_lds_dwordx4 v210, s[54:55] offset:1024 nt
    global_load_lds_dwordx4 v211, s[54:55] offset:2048 nt
    global_load_lds_dwordx4 v211, s[54:55] offset:3072 nt
    s_waitcnt vmcnt(9)
    s_mov_b64 exec, 1
    ds_add_u32 v12, v7 offset:16
    s_mov_b64 exec, -1
    v_and_b32 v1, 1, v3
    v_mul_u32_u24 v204, 14336, v1
    v_lshrrev_b32 v1, 1, v3
    v_lshl_add_u32 v204, v1, 8, v204
    v_lshl_add_u32 v204, v2, 4, v204
    s_mul_i32 s96, s32, 229376
    s_mul_i32 s97, s28, 896
    s_add_u32 s96, s96, s97
    s_and_b32 s97, s29, 1
    s_xor_b32 s99, s97, 1
    s_mov_b32 s48, 0
    s_mul_i32 s49, s99, 0xff00ff00
    v_subrev_u32 v1, 0x80, v204
    v_cndmask_b32 v217, v204, v1, s[48:49]
    s_mul_i32 s49, s97, 0xff00ff00
    s_lshl_b32 s99, s99, 9
    s_add_u32 s99, s99, s96
    s_lshl_b32 s97, s97, 9
    s_add_u32 s96, s96, s97
    v_cndmask_b32 v204, v204, v1, s[48:49]
    v_lshrrev_b32 v1, 3, v0
    v_lshl_add_u32 v207, v1, 4, v12
    v_and_b32 v1, 1, v0
    v_lshlrev_b32 v208, 4, v1
    s_mov_b32 s46, 0xff00ff00
    s_mov_b32 s47, 0xff00ff00
    s_mov_b32 s50, 0x101
    s_mov_b32 s51, 0
    s_add_u32 s52, s16, s96
    s_addc_u32 s53, s17, 0
    s_add_u32 s54, s18, s99
    s_addc_u32 s55, s19, 0
    s_add_u32 s56, s52, 7168
    s_addc_u32 s57, s53, 0
    s_add_u32 s58, s54, 7168
    s_addc_u32 s59, s55, 0
    s_waitcnt vmcnt(0)
    s_mov_b64 exec, 1
    ds_add_u32 v6, v7 offset:36
    s_mov_b64 exec, -1
    v_lshlrev_b32 v205, 16, v205
gt_21:
    ds_read_b32 v1, v6 offset:32
    s_waitcnt lgkmcnt(0)
    v_readfirstlane_b32 s96, v1
    s_cmp_ge_u32 s96, 4
    s_cbranch_scc1 gd_22
    s_sleep 1
    s_sub_u32 s40, s40, 1
    s_cbranch_scc0 gt_21
    s_mov_b32 s40, 0
gd_22:
    global_load_dwordx4 v[16:19], v204, s[52:53] nt
    global_load_dwordx4 v[80:83], v217, s[54:55] nt
    global_load_dwordx4 v[20:23], v204, s[56:57] nt
    v_add_u32 v204, 28672, v204
    global_load_dwordx4 v[84:87], v217, s[58:59] nt
    v_add_u32 v217, 28672, v217
    global_load_dwordx4 v[24:27], v204, s[52:53] nt
    global_load_dwordx4 v[88:91], v217, s[54:55] nt
    global_load_dwordx4 v[28:31], v204, s[56:57] nt
    v_add_u32 v204, 28672, v204
    global_load_dwordx4 v[92:95], v217, s[58:59] nt
    v_add_u32 v217, 28672, v217
gt_23:
    ds_read_b32 v1, v6 offset:64
    s_waitcnt lgkmcnt(0)
    v_readfirstlane_b32 s96, v1
    s_cmp_ge_u32 s96, 4
    s_cbranch_scc1 gd_24
    s_sleep 1
    s_sub_u32 s40, s40, 1
    s_cbranch_scc0 gt_23
    s_mov_b32 s40, 0
gd_24:
    global_load_dwordx4 v[32:35], v204, s[52:53] nt
    global_load_dwordx4 v[96:99], v217, s[54:55] nt
    global_load_dwordx4 v[36:39], v204, s[56:57] nt
    v_add_u32 v204, 28672, v204
    global_load_dwordx4 v[100:103], v217, s[58:59] nt
    v_add_u32 v217, 28672, v217
    global_load_dwordx4 v[40:43], v204, s[52:53] nt
    global_load_dwordx4 v[104:107], v217, s[54:55] nt
    global_load_dwordx4 v[44:47], v204, s[56:57] nt
    v_add_u32 v204, 28672, v204
    global_load_dwordx4 v[108:111], v217, s[58:59] nt
    v_add_u32 v217, 28672, v217
    global_load_dwordx4 v[48:51], v204, s[52:53] nt
    global_load_dwordx4 v[112:115], v217, s[54:55] nt
    global_load_dwordx4 v[52:55], v204, s[56:57] nt
    v_add_u32 v204, 28672, v204
    global_load_dwordx4 v[116:119], v217, s[58:59] nt
    v_add_u32 v217, 28672, v217
    global_load_dwordx4 v[56:59], v204, s[52:53] nt
    global_load_dwordx4 v[120:123], v217, s[54:55] nt
    global_load_dwordx4 v[60:63], v204, s[56:57] nt
    v_add_u32 v204, 28672, v204
    global_load_dwordx4 v[124:127], v217, s[58:59] nt
    v_add_u32 v217, 28672, v217
    s_waitcnt vmcnt(19)
    v_mfma_f32_16x16x32_bf16 v[152:155], v[168:171], v[16:19], 0
    v_mfma_f32_16x16x32_bf16 v[156:159], v[168:171], v[80:83], 0
    v_mfma_f32_16x16x32_bf16 v[152:155], v[168:171], v[20:23], v[152:155]
    v_mfma_f32_16x16x32_bf16 v[156:159], v[168:171], v[84:87], v[156:159]
    v_mfma_f32_16x16x32_bf16 v[152:155], v[168:171], v[24:27], v[152:155]
    global_load_dwordx4 v[64:67], v204, s[52:53] nt
    s_waitcnt vmcnt(19)
    v_mfma_f32_16x16x32_bf16 v[156:159], v[168:171], v[88:91], v[156:159]
    global_load_dwordx4 v[128:131], v217, s[54:55] nt
    s_waitcnt vmcnt(19)
    v_mfma_f32_16x16x32_bf16 v[152:155], v[168:171], v[28:31], v[152:155]
    global_load_dwordx4 v[68:71], v204, s[56:57] nt
    v_add_u32 v204, 28672, v204
    s_waitcnt vmcnt(19)
    v_mfma_f32_16x16x32_bf16 v[156:159], v[168:171], v[92:95], v[156:159]
    global_load_dwordx4 v[132:135], v217, s[58:59] nt
    v_add_u32 v217, 28672, v217
    s_waitcnt vmcnt(19)
    v_mfma_f32_16x16x32_bf16 v[152:155], v[168:171], v[32:35], v[152:155]
    global_load_dwordx4 v[72:75], v204, s[52:53] nt
    s_waitcnt vmcnt(19)
    v_mfma_f32_16x16x32_bf16 v[156:159], v[168:171], v[96:99], v[156:159]
    global_load_dwordx4 v[136:139], v217, s[54:55] nt
    s_waitcnt vmcnt(19)
    v_mfma_f32_16x16x32_bf16 v[152:155], v[168:171], v[36:39], v[152:155]
    global_load_dwordx4 v[76:79], v204, s[56:57] nt
    s_waitcnt vmcnt(19)
    v_mfma_f32_16x16x32_bf16 v[156:159], v[168:171], v[100:103], v[156:159]
    global_load_dwordx4 v[140:143], v217, s[58:59] nt
    s_lshl_b32 s97, s32, 12
    s_add_u32 s97, s97, 786432
    s_add_u32 s56, s26, s97
    s_addc_u32 s57, s27, 0
    s_xor_b32 s96, s29, 0
    s_and_b32 s96, s96, 1
    s_lshl_b32 s97, s96, 15
    s_lshr_b32 s98, s29, 1
    s_lshl_b32 s98, s98, 7
    s_add_u32 s97, s97, s98
    s_lshl_b32 s98, s28, 16
    s_add_u32 s97, s97, s98
    s_add_u32 s97, s97, 1048576
    s_cmp_eq_u32 s96, 0
    s_mov_b32 s60, -1
    s_cselect_b32 s61, -1, 0xffff
    v_lshrrev_b32 v1, 3, v0
    v_lshlrev_b32 v206, 12, v1
    v_and_b32 v1, 7, v0
    v_lshl_add_u32 v206, v1, 4, v206
    s_add_u32 s58, s26, s97
    s_addc_u32 s59, s27, 0
    s_xor_b32 s96, s29, 1
    s_and_b32 s96, s96, 1
    s_lshl_b32 s97, s96, 15
    s_lshr_b32 s98, s29, 1
    s_lshl_b32 s98, s98, 7
    s_add_u32 s97, s97, s98
    s_lshl_b32 s98, s28, 16
    s_add_u32 s97, s97, s98
    s_add_u32 s97, s97, 1048576
    s_cmp_eq_u32 s96, 0
    s_mov_b32 s54, -1
    s_cselect_b32 s55, -1, 0xffff
    s_add_u32 s52, s26, s97
    s_addc_u32 s53, s27, 0
    s_waitcnt vmcnt(18)
    v_mfma_f32_16x16x32_bf16 v[152:155], v[168:171], v[40:43], v[152:155]
    v_mfma_f32_16x16x32_bf16 v[156:159], v[168:171], v[104:107], v[156:159]
    s_waitcnt vmcnt(16)
    v_mfma_f32_16x16x32_bf16 v[152:155], v[168:171], v[44:47], v[152:155]
    v_mfma_f32_16x16x32_bf16 v[156:159], v[168:171], v[108:111], v[156:159]
    s_waitcnt vmcnt(14)
    v_mfma_f32_16x16x32_bf16 v[152:155], v[168:171], v[48:51], v[152:155]
    v_mfma_f32_16x16x32_bf16 v[156:159], v[168:171], v[112:115], v[156:159]
    s_waitcnt vmcnt(12)
    v_mfma_f32_16x16x32_bf16 v[152:155], v[168:171], v[52:55], v[152:155]
    v_mfma_f32_16x16x32_bf16 v[156:159], v[168:171], v[116:119], v[156:159]
    s_waitcnt vmcnt(10)
    v_mfma_f32_16x16x32_bf16 v[152:155], v[168:171], v[56:59], v[152:155]
    v_mfma_f32_16x16x32_bf16 v[156:159], v[168:171], v[120:123], v[156:159]
    s_waitcnt vmcnt(8)
    v_mfma_f32_16x16x32_bf16 v[152:155], v[168:171], v[60:63], v[152:155]
    v_mfma_f32_16x16x32_bf16 v[156:159], v[168:171], v[124:127], v[156:159]
    s_waitcnt vmcnt(6)
    v_mfma_f32_16x16x32_bf16 v[152:155], v[168:171], v[64:67], v[152:155]
    v_mfma_f32_16x16x32_bf16 v[156:159], v[168:171], v[128:131], v[156:159]
    s_waitcnt vmcnt(4)
    v_mfma_f32_16x16x32_bf16 v[152:155], v[168:171], v[68:71], v[152:155]
    v_mfma_f32_16x16x32_bf16 v[156:159], v[168:171], v[132:135], v[156:159]
    s_waitcnt vmcnt(2)
    v_mfma_f32_16x16x32_bf16 v[152:155], v[168:171], v[72:75], v[152:155]
    v_mfma_f32_16x16x32_bf16 v[156:159], v[168:171], v[136:139], v[156:159]
    s_waitcnt vmcnt(0)
    v_mfma_f32_16x16x32_bf16 v[152:155], v[168:171], v[76:79], v[152:155]
    v_mfma_f32_16x16x32_bf16 v[156:159], v[168:171], v[140:143], v[156:159]
    s_nop 6
    ds_write_b128 v13, v[152:155] offset:10752
    ds_write_b128 v13, v[156:159] offset:12800
    s_mov_b64 exec, 1
    ds_add_u32 v6, v7 offset:52
    s_mov_b64 exec, -1
pl_25:
    global_load_dwordx4 v[172:175], v14, s[56:57] offset:0 sc1
    global_load_dwordx4 v[176:179], v14, s[56:57] offset:1024 sc1
    global_load_dwordx4 v[180:183], v14, s[56:57] offset:2048 sc1
    global_load_dwordx4 v[184:187], v14, s[56:57] offset:3072 sc1
    s_waitcnt vmcnt(0)
    v_xor_b32 v172, v172, v5
    v_xor_b32 v176, v176, v5
    v_xor_b32 v180, v180, v5
    v_xor_b32 v184, v184, v5
    v_or3_b32 v1, v172, v176, v180
    v_or_b32 v1, v1, v184
    v_cmp_ne_u32_sdwa vcc, v1, v6 src0_sel:BYTE_0 src1_sel:DWORD
    s_cbranch_vccz pd_26
    s_sub_u32 s40, s40, 1
    s_cbranch_scc0 pl_25
    s_mov_b32 s40, 0
pd_26:
    s_setprio 3
    v_pk_add_f32 v[172:173], v[172:173], v[176:177]
    v_pk_add_f32 v[180:181], v[180:181], v[184:185]
    v_pk_add_f32 v[174:175], v[174:175], v[178:179]
    v_pk_add_f32 v[182:183], v[182:183], v[186:187]
    v_pk_add_f32 v[172:173], v[172:173], v[180:181]
    v_pk_add_f32 v[174:175], v[174:175], v[182:183]
    s_nop 1
    v_permlane16_swap_b32 v172, v174
    v_permlane16_swap_b32 v173, v175
    v_pk_add_f32 v[172:173], v[172:173], v[174:175]
    s_nop 1
    v_permlane32_swap_b32 v172, v173
    v_add_f32 v212, v172, v173
    s_nop 1
    v_add_f32_dpp v212, v212, v212 row_ror:8 row_mask:0xf bank_mask:0xf
    v_cvt_pk_bf16_f32 v212, v212, v212
    v_lshlrev_b32 v212, 16, v212
    v_add_f32 v212, v212, v205
    v_mov_b32 v214, v212
    v_cvt_pk_bf16_f32 v15, v212, v212
    s_nop 0
    v_permlane16_swap_b32 v212, v214
    v_cvt_pk_bf16_f32 v219, v212, v214
    s_nop 1
    v_and_b32_dpp v160, v219, v8 row_newbcast:0 row_mask:0xf bank_mask:0xf
    v_and_b32_dpp v161, v219, v9 row_newbcast:0 row_mask:0xf bank_mask:0xf
    v_and_b32_dpp v162, v219, v10 row_newbcast:0 row_mask:0xf bank_mask:0xf
    v_and_b32_dpp v163, v219, v11 row_newbcast:0 row_mask:0xf bank_mask:0xf
    v_and_b32_dpp v164, v219, v8 row_newbcast:1 row_mask:0xf bank_mask:0xf
    v_and_b32_dpp v165, v219, v9 row_newbcast:1 row_mask:0xf bank_mask:0xf
    v_and_b32_dpp v166, v219, v10 row_newbcast:1 row_mask:0xf bank_mask:0xf
    v_and_b32_dpp v167, v219, v11 row_newbcast:1 row_mask:0xf bank_mask:0xf
    v_smfmac_f32_16x16x64_bf16 v[144:147], v[160:163], v[16:23], v218
    v_lshlrev_b32 v212, 16, v15
    v_smfmac_f32_16x16x64_bf16 v[148:151], v[160:163], v[80:87], v218
    v_cndmask_b32 v213, 1.0, v212, s[46:47]
    v_and_b32_dpp v160, v219, v8 row_newbcast:2 row_mask:0xf bank_mask:0xf
    v_and_b32_dpp v161, v219, v9 row_newbcast:2 row_mask:0xf bank_mask:0xf
    v_and_b32_dpp v162, v219, v10 row_newbcast:2 row_mask:0xf bank_mask:0xf
    v_and_b32_dpp v163, v219, v11 row_newbcast:2 row_mask:0xf bank_mask:0xf
    v_smfmac_f32_16x16x64_bf16 v[144:147], v[164:167], v[24:31], v218
    v_mul_f32 v213, v213, v212
    v_smfmac_f32_16x16x64_bf16 v[148:151], v[164:167], v[88:95], v218
    s_nop 0
    v_add_f32_dpp v213, v213, v213 quad_perm:[1,0,3,2] row_mask:0xf bank_mask:0xf
    v_and_b32_dpp v164, v219, v8 row_newbcast:3 row_mask:0xf bank_mask:0xf
    v_and_b32_dpp v165, v219, v9 row_newbcast:3 row_mask:0xf bank_mask:0xf
    v_and_b32_dpp v166, v219, v10 row_newbcast:3 row_mask:0xf bank_mask:0xf
    v_and_b32_dpp v167, v219, v11 row_newbcast:3 row_mask:0xf bank_mask:0xf
    v_smfmac_f32_16x16x64_bf16 v[144:147], v[160:163], v[32:39], v218
    v_add_f32_dpp v213, v213, v213 quad_perm:[2,3,0,1] row_mask:0xf bank_mask:0xf
    v_smfmac_f32_16x16x64_bf16 v[148:151], v[160:163], v[96:103], v218
    s_nop 0
    v_add_f32_dpp v213, v213, v213 row_half_mirror row_mask:0xf bank_mask:0xf
    v_and_b32_dpp v160, v219, v8 row_newbcast:4 row_mask:0xf bank_mask:0xf
    v_and_b32_dpp v161, v219, v9 row_newbcast:4 row_mask:0xf bank_mask:0xf
    v_and_b32_dpp v162, v219, v10 row_newbcast:4 row_mask:0xf bank_mask:0xf
    v_and_b32_dpp v163, v219, v11 row_newbcast:4 row_mask:0xf bank_mask:0xf
    v_smfmac_f32_16x16x64_bf16 v[144:147], v[164:167], v[40:47], v218
    v_mov_b32 v214, v213
    v_smfmac_f32_16x16x64_bf16 v[148:151], v[164:167], v[104:111], v218
    s_nop 0
    v_permlane32_swap_b32 v213, v214
    v_and_b32_dpp v164, v219, v8 row_newbcast:5 row_mask:0xf bank_mask:0xf
    v_and_b32_dpp v165, v219, v9 row_newbcast:5 row_mask:0xf bank_mask:0xf
    v_and_b32_dpp v166, v219, v10 row_newbcast:5 row_mask:0xf bank_mask:0xf
    v_and_b32_dpp v167, v219, v11 row_newbcast:5 row_mask:0xf bank_mask:0xf
    v_smfmac_f32_16x16x64_bf16 v[144:147], v[160:163], v[48:55], v218
    v_add_f32 v213, v213, v214
    v_smfmac_f32_16x16x64_bf16 v[148:151], v[160:163], v[112:119], v218
    v_mov_b32 v214, v213
    v_and_b32_dpp v160, v219, v8 row_newbcast:6 row_mask:0xf bank_mask:0xf
    v_and_b32_dpp v161, v219, v9 row_newbcast:6 row_mask:0xf bank_mask:0xf
    v_and_b32_dpp v162, v219, v10 row_newbcast:6 row_mask:0xf bank_mask:0xf
    v_and_b32_dpp v163, v219, v11 row_newbcast:6 row_mask:0xf bank_mask:0xf
    v_smfmac_f32_16x16x64_bf16 v[144:147], v[164:167], v[56:63], v218
    v_permlane16_swap_b32 v213, v214
    v_smfmac_f32_16x16x64_bf16 v[148:151], v[164:167], v[120:127], v218
    v_add_f32 v213, v213, v214
    v_and_b32_dpp v164, v219, v8 row_newbcast:7 row_mask:0xf bank_mask:0xf
    v_and_b32_dpp v165, v219, v9 row_newbcast:7 row_mask:0xf bank_mask:0xf
    v_and_b32_dpp v166, v219, v10 row_newbcast:7 row_mask:0xf bank_mask:0xf
    v_and_b32_dpp v167, v219, v11 row_newbcast:7 row_mask:0xf bank_mask:0xf
    v_smfmac_f32_16x16x64_bf16 v[144:147], v[160:163], v[64:71], v218
    s_mov_b64 exec, s[50:51]
    ds_write_b32 v207, v213 offset:4608
    s_mov_b64 exec, -1
    v_smfmac_f32_16x16x64_bf16 v[148:151], v[160:163], v[128:135], v218
    v_smfmac_f32_16x16x64_bf16 v[144:147], v[164:167], v[72:79], v218
    v_smfmac_f32_16x16x64_bf16 v[148:151], v[164:167], v[136:143], v218
    s_nop 6
    ds_write_b128 v13, v[144:147] offset:9728
    ds_write_b128 v13, v[148:151] offset:11776
    s_mov_b64 exec, 1
    ds_add_rtn_u32 v1, v6, v7 offset:48
    s_mov_b64 exec, -1
    ds_read_b32 v215, v6 offset:60
    ds_read_b128 v[160:163], v208 offset:4608
    ds_read_b128 v[172:175], v14 offset:9728
    ds_read_b128 v[176:179], v14 offset:13824
    ds_read_b128 v[180:183], v14 offset:17920
    ds_read_b128 v[184:187], v14 offset:22016
    ds_read_b128 v[188:191], v14 offset:11776
    ds_read_b128 v[192:195], v14 offset:15872
    ds_read_b128 v[196:199], v14 offset:19968
    ds_read_b128 v[200:203], v14 offset:24064
    s_waitcnt lgkmcnt(10)
    v_readfirstlane_b32 s96, v1
    s_cmp_eq_u32 s96, 3
    s_cbranch_scc0 pub_27
    s_waitcnt lgkmcnt(4)
    v_readfirstlane_b32 s41, v215
    v_pk_add_f32 v[160:161], v[160:161], v[162:163]
    v_add_f32 v160, v160, v161
    v_pk_add_f32 v[172:173], v[172:173], v[176:177]
    v_pk_add_f32 v[180:181], v[180:181], v[184:185]
    v_pk_add_f32 v[174:175], v[174:175], v[178:179]
    v_pk_add_f32 v[182:183], v[182:183], v[186:187]
    v_pk_add_f32 v[172:173], v[172:173], v[180:181]
    v_pk_add_f32 v[174:175], v[174:175], v[182:183]
    v_perm_b32 v172, v172, v4, s34
    v_perm_b32 v173, v173, v160, s35
    v_perm_b32 v174, v174, v160, s36
    v_perm_b32 v175, v175, v160, s37
    s_mov_b64 exec, s[60:61]
    s_cmp_eq_u32 s41, 1
    s_cbranch_scc1 ls_28
    global_store_dwordx4 v206, v[172:175], s[58:59] sc1
    s_branch le_29
ls_28:
    global_store_dwordx4 v206, v[172:175], s[58:59]
le_29:
    s_mov_b64 exec, s[54:55]
    s_waitcnt lgkmcnt(0)
    v_pk_add_f32 v[188:189], v[188:189], v[192:193]
    v_pk_add_f32 v[196:197], v[196:197], v[200:201]
    v_pk_add_f32 v[190:191], v[190:191], v[194:195]
    v_pk_add_f32 v[198:199], v[198:199], v[202:203]
    v_pk_add_f32 v[188:189], v[188:189], v[196:197]
    v_pk_add_f32 v[190:191], v[190:191], v[198:199]
    v_perm_b32 v188, v188, v4, s34
    s_cmp_eq_u32 s41, 1
    s_cbranch_scc1 ls_30
    global_store_dwordx4 v206, v[188:191], s[52:53] offset:2048 sc1
    s_branch le_31
ls_30:
    global_store_dwordx4 v206, v[188:191], s[52:53] offset:2048
le_31:
    s_mov_b64 exec, -1
pub_27:
    s_waitcnt lgkmcnt(0)
    s_setprio 0
    s_and_b32 s96, s32, 7
    s_cmp_eq_u32 s96, s28
    s_cbranch_scc0 L_out
    s_bitcmp1_b32 s29, 0
    s_cbranch_scc0 L_out
    s_lshl_b32 s97, s32, 12
    s_add_u32 s97, s97, 917504
    s_add_u32 s56, s26, s97
    s_addc_u32 s57, s27, 0
    global_load_dwordx4 v[16:19], v14, s[56:57] offset:0 sc1
    global_load_dwordx4 v[20:23], v14, s[56:57] offset:1024 sc1
    global_load_dwordx4 v[24:27], v14, s[56:57] offset:2048 sc1
    global_load_dwordx4 v[28:31], v14, s[56:57] offset:3072 sc1
    s_sleep 10
    global_load_dwordx4 v[32:35], v14, s[56:57] offset:0 sc1
    global_load_dwordx4 v[36:39], v14, s[56:57] offset:1024 sc1
    global_load_dwordx4 v[40:43], v14, s[56:57] offset:2048 sc1
    global_load_dwordx4 v[44:47], v14, s[56:57] offset:3072 sc1
pt_32:
    s_waitcnt vmcnt(4)
    v_xor_b32 v16, v16, v5
    v_xor_b32 v20, v20, v5
    v_xor_b32 v24, v24, v5
    v_xor_b32 v28, v28, v5
    v_or3_b32 v1, v16, v20, v24
    v_or_b32 v1, v1, v28
    v_cmp_ne_u32_sdwa vcc, v1, v6 src0_sel:BYTE_0 src1_sel:DWORD
    s_cbranch_vccz pk_34
    global_load_dwordx4 v[16:19], v14, s[56:57] offset:0 sc1
    global_load_dwordx4 v[20:23], v14, s[56:57] offset:1024 sc1
    global_load_dwordx4 v[24:27], v14, s[56:57] offset:2048 sc1
    global_load_dwordx4 v[28:31], v14, s[56:57] offset:3072 sc1
    s_waitcnt vmcnt(4)
    v_xor_b32 v32, v32, v5
    v_xor_b32 v36, v36, v5
    v_xor_b32 v40, v40, v5
    v_xor_b32 v44, v44, v5
    v_or3_b32 v1, v32, v36, v40
    v_or_b32 v1, v1, v44
    v_cmp_ne_u32_sdwa vcc, v1, v6 src0_sel:BYTE_0 src1_sel:DWORD
    s_cbranch_vccz pk_35
    global_load_dwordx4 v[32:35], v14, s[56:57] offset:0 sc1
    global_load_dwordx4 v[36:39], v14, s[56:57] offset:1024 sc1
    global_load_dwordx4 v[40:43], v14, s[56:57] offset:2048 sc1
    global_load_dwordx4 v[44:47], v14, s[56:57] offset:3072 sc1
    s_sub_u32 s40, s40, 1
    s_cbranch_scc0 pt_32
    s_mov_b32 s40, 0
    s_waitcnt vmcnt(0)
pk_34:
    v_pk_add_f32 v[172:173], v[16:17], v[20:21]
    v_pk_add_f32 v[174:175], v[18:19], v[22:23]
    v_pk_add_f32 v[180:181], v[24:25], v[28:29]
    v_pk_add_f32 v[182:183], v[26:27], v[30:31]
    s_branch pz_33
pk_35:
    v_pk_add_f32 v[172:173], v[32:33], v[36:37]
    v_pk_add_f32 v[174:175], v[34:35], v[38:39]
    v_pk_add_f32 v[180:181], v[40:41], v[44:45]
    v_pk_add_f32 v[182:183], v[42:43], v[46:47]
pz_33:
    v_pk_add_f32 v[172:173], v[172:173], v[180:181]
    v_pk_add_f32 v[174:175], v[174:175], v[182:183]
    s_nop 1
    v_permlane16_swap_b32 v172, v174
    v_permlane16_swap_b32 v173, v175
    v_pk_add_f32 v[172:173], v[172:173], v[174:175]
    s_nop 1
    v_permlane32_swap_b32 v172, v173
    v_add_f32 v213, v172, v173
    s_nop 1
    v_add_f32_dpp v213, v213, v213 row_ror:8 row_mask:0xf bank_mask:0xf
    s_mov_b32 exec_lo, 0x00ff00ff
    s_mov_b32 exec_hi, 0x00ff00ff
    v_cvt_pk_bf16_f32 v213, v213, v213
    v_lshlrev_b32 v213, 16, v213
    v_add_f32 v213, v213, v212
    v_cvt_pk_bf16_f32 v213, v213, v213
    global_store_short v209, v213, s[22:23] sc1
    s_mov_b64 exec, 1
    s_cmp_eq_u32 s32, 0
    s_cbranch_scc0 L_fin
    global_store_dword v6, v4, s[26:27] sc1
L_fin:
    s_mov_b64 exec, -1
    s_branch L_out
L_AX:
    s_and_b32 s32, s28, 1
    s_lshl_b32 s32, s32, 4
    s_add_u32 s32, s32, s29
    s_lshl_b32 s99, s31, 13
    s_lshl_b32 s96, s30, 14
    s_lshl_b32 s97, s31, 12
    s_add_u32 s96, s96, s97
    s_add_u32 s96, s96, 65536
    s_add_u32 s56, s26, s96
    s_addc_u32 s57, s27, 0
    s_lshl_b32 s96, s30, 17
    s_add_u32 s96, s96, 262144
    s_add_u32 s58, s26, s96
    s_addc_u32 s59, s27, 0
    v_xor_b32 v1, v3, v2
    v_lshlrev_b32 v1, 4, v1
    v_lshl_add_u32 v152, v2, 8, v1
    v_add_u32 v152, s99, v152
    v_xor_b32 v153, 64, v152
    v_xor_b32 v154, 0x80, v152
    v_xor_b32 v155, 0xc0, v152
    v_lshrrev_b32 v1, 5, v0
    v_mul_u32_u24 v156, 288, v1
    v_and_b32 v1, 31, v0
    v_lshl_add_u32 v156, v1, 3, v156
    s_mul_i32 s96, s31, 576
    v_add_u32 v156, s96, v156
    v_and_b32 v164, 7, v2
    v_mul_u32_u24 v157, 288, v164
    v_lshl_add_u32 v157, v3, 4, v157
    v_lshrrev_b32 v1, 1, v3
    v_lshlrev_b32 v158, 8, v1
    v_lshrrev_b32 v1, 3, v2
    v_lshl_add_u32 v158, v1, 9, v158
    v_lshl_add_u32 v158, v164, 4, v158
    v_and_b32 v1, 1, v3
    v_lshl_add_u32 v158, v1, 3, v158
    s_and_b32 s96, s31, 1
    s_lshl_b32 s96, s96, 7
    s_lshr_b32 s97, s31, 1
    s_lshl_b32 s97, s97, 10
    s_add_u32 s96, s96, s97
    v_add_u32 v158, s96, v158
    v_lshrrev_b32 v165, 2, v2
    v_lshl_add_u32 v166, v1, 2, v165
    v_lshlrev_b32 v166, 1, v166
    v_and_b32 v167, 3, v2
    v_lshrrev_b32 v168, 1, v167
    s_lshl_b32 s96, s31, 2
    v_add_u32 v168, s96, v168
    v_xor_b32 v168, v168, v166
    v_lshlrev_b32 v168, 4, v168
    v_and_b32 v167, 1, v167
    v_lshl_add_u32 v168, v167, 3, v168
    v_lshl_add_u32 v165, v3, 3, v165
    v_lshl_add_u32 v159, v165, 8, v168
    v_add_u32 v159, 59392, v159
    v_xor_b32 v160, 32, v159
    v_mul_u32_u24 v161, 144, v164
    v_lshrrev_b32 v1, 3, v2
    v_lshl_add_u32 v1, v1, 2, v3
    v_lshl_add_u32 v161, v1, 4, v161
    s_mul_i32 s96, s31, 1152
    v_add_u32 v161, s96, v161
    v_lshrrev_b32 v165, 3, v0
    v_and_b32 v166, 7, v0
    v_mul_u32_u24 v162, 144, v165
    v_lshl_add_u32 v162, v166, 4, v162
    v_add_u32 v162, s96, v162
    v_lshlrev_b32 v165, 2, v165
    v_add_u32 v165, s31, v165
    v_add_u32 v1, s32, v165
    v_and_b32 v1, 31, v1
    v_lshlrev_b32 v1, 7, v1
    v_lshl_add_u32 v163, v165, 12, v1
    v_lshl_add_u32 v163, v166, 4, v163
    s_mov_b32 s48, 0xff00ff00
    s_mov_b32 s49, 0xff00ff00
    s_mov_b32 s50, 0x3db504f3
    s_mov_b32 s51, 0x3db504f3
    s_mov_b32 s46, 0xffff0000
    s_mov_b32 s47, 0xffff0000
    v_mov_b32 v144, 0x3f803f80
    v_mov_b32 v145, 0x3f803f80
    v_mov_b32 v146, 0x3f803f80
    v_mov_b32 v147, 0x3f803f80
gt_36:
    ds_read_b32 v1, v12 offset:16
    s_waitcnt lgkmcnt(0)
    v_readfirstlane_b32 s96, v1
    s_cmp_ge_u32 s96, 1
    s_cbranch_scc1 gd_37
    s_sleep 1
    s_sub_u32 s40, s40, 1
    s_cbranch_scc0 gt_36
    s_mov_b32 s40, 0
gd_37:
    ds_read_b128 v[16:19], v152 offset:26624
    ds_read_b128 v[20:23], v153 offset:26624
    ds_read_b128 v[24:27], v154 offset:26624
    ds_read_b128 v[28:31], v155 offset:26624
    ds_read_b128 v[32:35], v152 offset:30720
    ds_read_b128 v[36:39], v153 offset:30720
    ds_read_b128 v[40:43], v154 offset:30720
    ds_read_b128 v[44:47], v155 offset:30720
gt_38:
    ds_read_b32 v1, v6 offset:36
    s_waitcnt lgkmcnt(0)
    v_readfirstlane_b32 s96, v1
    s_cmp_ge_u32 s96, 3
    s_cbranch_scc1 gd_39
    s_sleep 1
    s_sub_u32 s40, s40, 1
    s_cbranch_scc0 gt_38
    s_mov_b32 s40, 0
gd_39:
pl_40:
    global_load_dwordx4 v[80:83], v14, s[56:57] offset:0 sc1
    global_load_dwordx4 v[84:87], v14, s[56:57] offset:1024 sc1
    global_load_dwordx4 v[88:91], v14, s[56:57] offset:2048 sc1
    global_load_dwordx4 v[92:95], v14, s[56:57] offset:3072 sc1
    s_waitcnt vmcnt(0)
    v_xor_b32 v80, v80, v5
    v_xor_b32 v84, v84, v5
    v_xor_b32 v88, v88, v5
    v_xor_b32 v92, v92, v5
    v_or3_b32 v1, v80, v84, v88
    v_or_b32 v1, v1, v92
    v_cmp_ne_u32_sdwa vcc, v1, v6 src0_sel:BYTE_0 src1_sel:DWORD
    s_cbranch_vccz pd_41
    s_sub_u32 s40, s40, 1
    s_cbranch_scc0 pl_40
    s_mov_b32 s40, 0
pd_41:
    s_setprio 3
    v_pk_add_f32 v[80:81], v[80:81], v[84:85]
    v_pk_add_f32 v[82:83], v[82:83], v[86:87]
    v_pk_add_f32 v[88:89], v[88:89], v[92:93]
    v_pk_add_f32 v[90:91], v[90:91], v[94:95]
    s_nop 0
    v_permlane32_swap_b32 v80, v88
    v_permlane32_swap_b32 v81, v89
    v_permlane32_swap_b32 v82, v90
    v_permlane32_swap_b32 v83, v91
    v_pk_add_f32 v[80:81], v[80:81], v[88:89]
    v_pk_add_f32 v[82:83], v[82:83], v[90:91]
    v_cvt_pk_bf16_f32 v164, v80, v81
    v_cvt_pk_bf16_f32 v165, v82, v83
    ds_write_b64 v156, v[164:165] offset:256
    s_mov_b64 exec, 1
    ds_add_u32 v6, v7 offset:32
    s_mov_b64 exec, -1
qs_42:
    ds_read_b32 v1, v6 offset:32
    ds_read_b128 v[80:83], v157 offset:256
    ds_read_b128 v[84:87], v157 offset:320
    ds_read_b128 v[88:91], v157 offset:384
    ds_read_b128 v[92:95], v157 offset:448
    s_waitcnt lgkmcnt(0)
    v_readfirstlane_b32 s96, v1
    s_cmp_eq_u32 s96, 4
    s_cbranch_scc1 qsd_43
    s_sub_u32 s40, s40, 1
    s_cbranch_scc0 qs_42
    s_mov_b32 s40, 0
qsd_43:
    v_mfma_f32_16x16x32_bf16 v[96:99], v[16:19], v[80:83], 0
    v_mfma_f32_16x16x32_bf16 v[100:103], v[32:35], v[80:83], 0
    v_mfma_f32_16x16x32_bf16 v[96:99], v[20:23], v[84:87], v[96:99]
    v_mfma_f32_16x16x32_bf16 v[100:103], v[36:39], v[84:87], v[100:103]
    v_mfma_f32_16x16x32_bf16 v[96:99], v[24:27], v[88:91], v[96:99]
    v_mfma_f32_16x16x32_bf16 v[100:103], v[40:43], v[88:91], v[100:103]
    v_mfma_f32_16x16x32_bf16 v[96:99], v[28:31], v[92:95], v[96:99]
    v_mfma_f32_16x16x32_bf16 v[100:103], v[44:47], v[92:95], v[100:103]
    s_nop 7
    v_cndmask_b32 v96, v96, v100, s[48:49]
    v_cndmask_b32 v97, v97, v101, s[48:49]
    v_cndmask_b32 v98, v98, v102, s[48:49]
    v_cndmask_b32 v99, v99, v103, s[48:49]
    v_cvt_pk_bf16_f32 v164, v96, v97
    v_cvt_pk_bf16_f32 v165, v98, v99
    v_lshlrev_b32 v96, 16, v164
    v_and_b32 v97, 0xffff0000, v164
    v_lshlrev_b32 v98, 16, v165
    v_and_b32 v99, 0xffff0000, v165
    v_pk_mul_f32 v[96:97], v[96:97], s[50:51]
    v_pk_mul_f32 v[98:99], v[98:99], s[50:51]
    v_cvt_pk_bf16_f32 v164, v96, v97
    v_cvt_pk_bf16_f32 v165, v98, v99
    ds_write_b64 v158, v[164:165] offset:2560
    s_mov_b64 exec, 1
    ds_add_u32 v6, v7 offset:36
    s_mov_b64 exec, -1
ss_44:
    ds_read_b32 v1, v6 offset:36
    ds_read_b128 v[104:107], v14 offset:2560
    ds_read_b128 v[108:111], v14 offset:3584
    s_waitcnt lgkmcnt(0)
    v_readfirstlane_b32 s96, v1
    s_cmp_eq_u32 s96, 8
    s_cbranch_scc1 ssd_45
    s_sub_u32 s40, s40, 1
    s_cbranch_scc0 ss_44
    s_mov_b32 s40, 0
ssd_45:
    ds_read_b64_tr_b16 v[48:49], v159 offset:0
    ds_read_b64_tr_b16 v[50:51], v159 offset:1024
    ds_read_b64_tr_b16 v[64:65], v160 offset:0
    ds_read_b64_tr_b16 v[66:67], v160 offset:1024
    ds_read_b64_tr_b16 v[52:53], v159 offset:8192
    ds_read_b64_tr_b16 v[54:55], v159 offset:9216
    ds_read_b64_tr_b16 v[68:69], v160 offset:8192
    ds_read_b64_tr_b16 v[70:71], v160 offset:9216
    ds_read_b64_tr_b16 v[56:57], v159 offset:16384
    ds_read_b64_tr_b16 v[58:59], v159 offset:17408
    ds_read_b64_tr_b16 v[72:73], v160 offset:16384
    ds_read_b64_tr_b16 v[74:75], v160 offset:17408
    ds_read_b64_tr_b16 v[60:61], v159 offset:24576
    ds_read_b64_tr_b16 v[62:63], v159 offset:25600
    ds_read_b64_tr_b16 v[76:77], v160 offset:24576
    ds_read_b64_tr_b16 v[78:79], v160 offset:25600
    v_lshlrev_b32 v112, 16, v104
    v_and_b32 v113, 0xffff0000, v104
    v_lshlrev_b32 v114, 16, v105
    v_and_b32 v115, 0xffff0000, v105
    v_lshlrev_b32 v116, 16, v106
    v_and_b32 v117, 0xffff0000, v106
    v_lshlrev_b32 v118, 16, v107
    v_and_b32 v119, 0xffff0000, v107
    v_lshlrev_b32 v120, 16, v108
    v_and_b32 v121, 0xffff0000, v108
    v_lshlrev_b32 v122, 16, v109
    v_and_b32 v123, 0xffff0000, v109
    v_lshlrev_b32 v124, 16, v110
    v_and_b32 v125, 0xffff0000, v110
    v_lshlrev_b32 v126, 16, v111
    v_and_b32 v127, 0xffff0000, v111
    v_max3_f32 v164, v112, v113, v114
    v_max3_f32 v165, v115, v116, v117
    v_max3_f32 v166, v118, v119, v120
    v_max3_f32 v167, v121, v122, v123
    v_max3_f32 v164, v164, v124, v125
    v_max3_f32 v165, v165, v126, v127
    v_max3_f32 v164, v164, v166, v167
    v_max_f32 v164, v164, v165
    s_nop 1
    v_max_f32_dpp v164, v164, v164 row_ror:8 row_mask:0xf bank_mask:0xf
    v_mov_b32 v165, v164
    s_nop 1
    v_permlane16_swap_b32 v164, v165
    v_max_f32 v164, v164, v165
    v_mov_b32 v165, v164
    s_nop 1
    v_permlane32_swap_b32 v164, v165
    v_max_f32 v164, v164, v165
    v_pk_add_f32 v[112:113], v[112:113], v[164:165] op_sel_hi:[1,0] neg_lo:[0,1] neg_hi:[0,1]
    v_pk_add_f32 v[114:115], v[114:115], v[164:165] op_sel_hi:[1,0] neg_lo:[0,1] neg_hi:[0,1]
    v_pk_add_f32 v[116:117], v[116:117], v[164:165] op_sel_hi:[1,0] neg_lo:[0,1] neg_hi:[0,1]
    v_pk_add_f32 v[118:119], v[118:119], v[164:165] op_sel_hi:[1,0] neg_lo:[0,1] neg_hi:[0,1]
    v_pk_add_f32 v[120:121], v[120:121], v[164:165] op_sel_hi:[1,0] neg_lo:[0,1] neg_hi:[0,1]
    v_pk_add_f32 v[122:123], v[122:123], v[164:165] op_sel_hi:[1,0] neg_lo:[0,1] neg_hi:[0,1]
    v_pk_add_f32 v[124:125], v[124:125], v[164:165] op_sel_hi:[1,0] neg_lo:[0,1] neg_hi:[0,1]
    v_pk_add_f32 v[126:127], v[126:127], v[164:165] op_sel_hi:[1,0] neg_lo:[0,1] neg_hi:[0,1]
    v_pk_mul_f32 v[112:113], v[112:113], s[42:43]
    v_pk_mul_f32 v[114:115], v[114:115], s[42:43]
    v_pk_mul_f32 v[116:117], v[116:117], s[42:43]
    v_pk_mul_f32 v[118:119], v[118:119], s[42:43]
    v_pk_mul_f32 v[120:121], v[120:121], s[42:43]
    v_pk_mul_f32 v[122:123], v[122:123], s[42:43]
    v_pk_mul_f32 v[124:125], v[124:125], s[42:43]
    v_pk_mul_f32 v[126:127], v[126:127], s[42:43]
    v_exp_f32 v112, v112
    v_exp_f32 v113, v113
    v_exp_f32 v114, v114
    v_exp_f32 v115, v115
    v_exp_f32 v116, v116
    v_exp_f32 v117, v117
    v_exp_f32 v118, v118
    v_exp_f32 v119, v119
    v_cvt_pk_bf16_f32 v104, v112, v113
    v_cvt_pk_bf16_f32 v105, v114, v115
    v_cvt_pk_bf16_f32 v106, v116, v117
    v_cvt_pk_bf16_f32 v107, v118, v119
    s_waitcnt lgkmcnt(0)
    s_nop 0
    v_mfma_f32_16x16x32_bf16 v[96:99], v[144:147], v[104:107], 0
    v_mfma_f32_16x16x32_bf16 v[128:131], v[48:51], v[104:107], 0
    v_mfma_f32_16x16x32_bf16 v[132:135], v[52:55], v[104:107], 0
    v_mfma_f32_16x16x32_bf16 v[136:139], v[64:67], v[104:107], 0
    v_mfma_f32_16x16x32_bf16 v[140:143], v[68:71], v[104:107], 0
    v_exp_f32 v120, v120
    v_exp_f32 v121, v121
    v_exp_f32 v122, v122
    v_exp_f32 v123, v123
    v_exp_f32 v124, v124
    v_exp_f32 v125, v125
    v_exp_f32 v126, v126
    v_exp_f32 v127, v127
    v_cvt_pk_bf16_f32 v108, v120, v121
    v_cvt_pk_bf16_f32 v109, v122, v123
    v_cvt_pk_bf16_f32 v110, v124, v125
    v_cvt_pk_bf16_f32 v111, v126, v127
    s_nop 1
    v_mfma_f32_16x16x32_bf16 v[96:99], v[144:147], v[108:111], v[96:99]
    v_mfma_f32_16x16x32_bf16 v[128:131], v[56:59], v[108:111], v[128:131]
    v_mfma_f32_16x16x32_bf16 v[132:135], v[60:63], v[108:111], v[132:135]
    v_mfma_f32_16x16x32_bf16 v[136:139], v[72:75], v[108:111], v[136:139]
    v_mfma_f32_16x16x32_bf16 v[140:143], v[76:79], v[108:111], v[140:143]
    s_nop 3
    v_add_f32_dpp v166, v96, v96 row_ror:8 row_mask:0xf bank_mask:0xf
    v_cndmask_b32 v166, v164, v166, s[46:47]
    v_add_f32_dpp v112, v132, v128 row_ror:8 row_mask:0xf bank_mask:0x3
    v_add_f32_dpp v113, v133, v129 row_ror:8 row_mask:0xf bank_mask:0x3
    v_add_f32_dpp v114, v134, v130 row_ror:8 row_mask:0xf bank_mask:0x3
    v_add_f32_dpp v115, v135, v131 row_ror:8 row_mask:0xf bank_mask:0x3
    v_add_f32_dpp v112, v136, v140 row_ror:8 row_mask:0xf bank_mask:0xc
    v_add_f32_dpp v113, v137, v141 row_ror:8 row_mask:0xf bank_mask:0xc
    v_add_f32_dpp v114, v138, v142 row_ror:8 row_mask:0xf bank_mask:0xc
    v_add_f32_dpp v115, v139, v143 row_ror:8 row_mask:0xf bank_mask:0xc
    v_perm_b32 v112, v112, v4, s34
    v_perm_b32 v113, v113, v166, s35
    v_perm_b32 v114, v114, v166, s36
    v_perm_b32 v115, v115, v166, s37
    ds_write_b128 v161, v[112:115] offset:4864
    ds_read_b128 v[116:119], v162 offset:4864
    s_waitcnt lgkmcnt(0)
    global_store_dwordx4 v163, v[116:119], s[58:59] sc1
    s_mov_b64 exec, 1
    ds_add_u32 v6, v7 offset:64
    s_mov_b64 exec, -1
    s_setprio 0
    s_cmp_ge_u32 s31, 2
    s_cbranch_scc1 L_out
    s_getreg_b32 s96, hwreg(HW_REG_XCC_ID, 0, 4)
    s_add_u32 s96, s96, s33
    v_mov_b32 v165, s96
    s_lshl_b32 s97, s28, 7
    s_add_u32 s97, s97, 4096
    v_and_b32 v164, 31, v0
    v_lshl_add_u32 v164, v164, 2, s97
xt_46:
    global_load_dword v166, v164, s[26:27] sc1
    s_waitcnt vmcnt(0)
    v_sub_u32 v167, v166, v4
    v_cmp_le_u32 vcc, 16, v167
    s_cbranch_vccz xtd_47
    s_sleep 2
    s_sub_u32 s40, s40, 1
    s_cbranch_scc0 xt_46
    s_mov_b32 s40, 0
xtd_47:
    v_cmp_ne_u32 vcc, v166, v165
    s_cmp_eq_u64 vcc, 0
    s_cselect_b32 s41, 1, 2
    v_mov_b32 v166, s41
    ds_write_b32 v6, v166 offset:60
    s_xor_b32 s96, s29, s31
    s_and_b32 s96, s96, 1
    s_lshl_b32 s97, s96, 15
    s_lshr_b32 s98, s29, 1
    s_lshl_b32 s98, s98, 7
    s_add_u32 s97, s97, s98
    s_lshl_b32 s98, s28, 16
    s_add_u32 s97, s97, s98
    s_add_u32 s97, s97, 1048576
    s_cmp_eq_u32 s96, 0
    s_mov_b32 s60, -1
    s_cselect_b32 s61, -1, 0xffff
    v_lshrrev_b32 v1, 3, v0
    v_lshlrev_b32 v163, 12, v1
    v_and_b32 v1, 7, v0
    v_lshl_add_u32 v163, v1, 4, v163
    s_add_u32 s52, s26, s97
    s_addc_u32 s53, s27, 0
    s_lshl_b32 s96, s31, 11
    s_add_u32 s96, s96, 1024
    v_add_u32 v163, s96, v163
    v_add_u32 v164, s96, v14
gt_48:
    ds_read_b32 v1, v6 offset:52
    s_waitcnt lgkmcnt(0)
    v_readfirstlane_b32 s96, v1
    s_cmp_ge_u32 s96, 4
    s_cbranch_scc1 gd_49
    s_sleep 1
    s_sub_u32 s40, s40, 1
    s_cbranch_scc0 gt_48
    s_mov_b32 s40, 0
gd_49:
    ds_read_b128 v[16:19], v164 offset:9728
    ds_read_b128 v[20:23], v164 offset:13824
    ds_read_b128 v[24:27], v164 offset:17920
    ds_read_b128 v[28:31], v164 offset:22016
    s_waitcnt lgkmcnt(0)
    v_pk_add_f32 v[16:17], v[16:17], v[20:21]
    v_pk_add_f32 v[24:25], v[24:25], v[28:29]
    v_pk_add_f32 v[18:19], v[18:19], v[22:23]
    v_pk_add_f32 v[26:27], v[26:27], v[30:31]
    v_pk_add_f32 v[16:17], v[16:17], v[24:25]
    v_pk_add_f32 v[18:19], v[18:19], v[26:27]
    v_perm_b32 v16, v16, v4, s34
    s_mov_b64 exec, s[60:61]
    s_cmp_eq_u32 s41, 1
    s_cbranch_scc1 ls_50
    global_store_dwordx4 v163, v[16:19], s[52:53] sc1
    s_branch le_51
ls_50:
    global_store_dwordx4 v163, v[16:19], s[52:53]
le_51:
    s_mov_b64 exec, -1
L_out:
L_end:
    s_endpgm

.section .rodata,"a"
.p2align 6
.amdhsa_kernel sequential_preLN__sliding_block_cached__geglu_ffn__decode_kernel
  .amdhsa_next_free_vgpr 220
  .amdhsa_next_free_sgpr 102
  .amdhsa_accum_offset 220
  .amdhsa_group_segment_fixed_size 0
  .amdhsa_kernarg_size 96
  .amdhsa_user_sgpr_count 2
  .amdhsa_user_sgpr_kernarg_segment_ptr 1
  .amdhsa_system_sgpr_workgroup_id_x 1
.end_amdhsa_kernel
```
